```python
import torch

def _softmax(x, axis=-1):
    return torch.softmax(x, dim=axis)
def _gelu(x):
    return torch.nn.functional.gelu(x, approximate="tanh")
def _silu(x):
    return torch.nn.functional.silu(x)
def _sigmoid(x):
    return torch.sigmoid(x)
def _layernorm(x, axis=-1, eps=1e-5):
    m = x.mean(dim=axis, keepdim=True)
    v = x.var(dim=axis, keepdim=True, unbiased=False)
    return (x - m) / torch.sqrt(v + eps)
def _scatter_add(tgt, idx, src, axis=0):
    return tgt.clone().index_add_(axis, idx, src)
def _segment_sum(src, seg, n):
    out = torch.zeros((n,) + src.shape[1:], dtype=src.dtype)
    return out.index_add_(0, seg, src)
def _pad(x, pw):
    flat = tuple(v for pair in reversed(pw) for v in pair)
    return torch.nn.functional.pad(x, flat)

kernel_name = 'recurrent_scan__mha_block_cached__geglu_ffn__decode'

def setup_inputs():

    _w = (lambda a: (lambda t: t.to(torch.bfloat16) if t.is_floating_point() else t)(torch.as_tensor(a)))
    def _A_setup():
        B, Sq, D = 4, 1, 640
        H, Sk, Dh = 32, 8192, 128
        return {
            "x": _w((lambda *s: torch.randn(*s, dtype=torch.bfloat16) * 0.05)(B, Sq, D)),
            "k_cache": _w((lambda *s: torch.randn(*s, dtype=torch.bfloat16) * 1.6)(B, H, Sk, Dh)),
            "v_cache": _w((lambda *s: torch.randn(*s, dtype=torch.bfloat16) * 0.2)(B, H, Sk, Dh)),
            "wq": _w((lambda *s: torch.randn(*s, dtype=torch.bfloat16) * 1.6)(D, H * Dh) * (D ** -0.5)),
            "wo": _w((lambda *s: torch.randn(*s, dtype=torch.bfloat16) * 0.2)(H * Dh, D) * ((H * Dh) ** -0.5)),
        }
    _A_in = _A_setup()

    def _B_setup():
        B, S, D, F = 4, 1, 640, 1728
        return {
            "x": _w((lambda *s: torch.randn(*s, dtype=torch.bfloat16) * 0.05)(B, S, D)),
            "w_gate": _w((lambda *s: torch.randn(*s, dtype=torch.bfloat16) * 0.1)(D, F)),
            "w_up": _w((lambda *s: torch.randn(*s, dtype=torch.bfloat16) * 0.1)(D, F)),
            "w_down": _w((lambda *s: torch.randn(*s, dtype=torch.bfloat16) * 0.1)(F, D)),
        }
    _B_in = _B_setup()

    return {
        "A_x": _A_in["x"],
        "A_k_cache": _A_in["k_cache"],
        "A_v_cache": _A_in["v_cache"],
        "A_wq": _A_in["wq"],
        "A_wo": _A_in["wo"],
        "B_x": _B_in["x"],
        "B_w_gate": _B_in["w_gate"],
        "B_w_up": _B_in["w_up"],
        "B_w_down": _B_in["w_down"],
    }

def reference(A_x, A_k_cache, A_v_cache, A_wq, A_wo, B_x, B_w_gate, B_w_up, B_w_down):
    def _A_ref(x, k_cache, v_cache, wq, wo):
        B, Sq, D = x.shape
        H, Dh = 32, 128
        q = (lambda x, *d: x.permute(*d))((x @ wq).reshape(B, Sq, H, Dh), 0, 2, 1, 3)
        scores = torch.einsum("bhqd,bhkd->bhqk", q, k_cache) * (Dh ** -0.5)
        p = _softmax(scores, axis=-1)
        o = torch.einsum("bhqk,bhkd->bhqd", p, v_cache)
        return (lambda x, *d: x.permute(*d))(o, 0, 2, 1, 3).reshape(B, Sq, H * Dh) @ wo

    def _B_ref(x, w_gate, w_up, w_down):
        return (_gelu(x @ w_gate) * (x @ w_up)) @ w_down

    x = A_x
    xn = _layernorm(x, axis=-1)
    s = _A_ref(xn, A_k_cache, A_v_cache, A_wq, A_wo)
    g = _silu(_B_ref(xn, B_w_gate, B_w_up, B_w_down))
    return x + s * g
```

```asm
; @launch grid=(256,1,1) block=(512,1,1) lds=130912
.amdgcn_target "amdgcn-amd-amdhsa--gfx950"
.text
.globl recurrent_scan__mha_block_cached__geglu_ffn__decode_kernel
.p2align 8
.type recurrent_scan__mha_block_cached__geglu_ffn__decode_kernel,@function
recurrent_scan__mha_block_cached__geglu_ffn__decode_kernel:
    s_cmp_ge_u32 s2, 256
    s_cbranch_scc1 L_end
    s_load_dwordx16 s[36:51], s[0:1], 0
    s_load_dwordx8 s[52:59], s[0:1], 64
    v_lshrrev_b32 v4, 6, v0
    v_and_b32 v1, 63, v0
    v_readfirstlane_b32 s3, v4
    v_and_b32 v2, 15, v1
    v_lshrrev_b32 v3, 4, v1
    s_and_b32 s4, s2, 7
    s_lshr_b32 s5, s2, 3
    s_and_b32 s6, s5, 1
    s_lshr_b32 s7, s5, 1
    s_and_b32 s7, s7, 3
    s_lshr_b32 s60, s5, 3
    s_mul_i32 s61, s60, 0
    s_add_u32 s61, s61, s4
    s_and_b32 s61, s61, 7
    s_lshl_b32 s60, s60, 3
    s_add_u32 s60, s60, s61
    s_mov_b32 s68, 0x3fb8aa3b
    s_mov_b32 s69, 0x3db504f3
    v_and_b32 v8, 1, v2
    v_lshlrev_b32 v8, 4, v8
    v_mov_b32 v9, 0xffff
    v_lshlrev_b32 v8, v8, v9
    v_lshrrev_b32 v9, 1, v2
    s_lshr_b32 s61, 0x15, s4
    s_and_b32 s61, s61, 1
    s_lshl_b32 s61, s61, 2
    s_add_u32 s95, s61, 12
    s_cmp_lt_u32 s3, 4
    s_cbranch_scc0 L_str
L_aux:
    s_setprio 1
    s_mov_b32 s70, s3
    s_mov_b32 s94, 0x40000
    v_lshlrev_b32 v10, 2, v1
    v_mul_u32_u24 v11, 327680, v3
    v_lshl_add_u32 v11, v2, 4, v11
    s_mul_i32 s61, s70, 1280
    s_mul_i32 s64, s7, 1280
    s_mul_i32 s62, s60, 256
    s_mul_i32 s63, s70, 1310720
    s_add_u32 s62, s62, s63
    s_sub_u32 s63, 5242880, s62
    s_waitcnt lgkmcnt(0)
    s_mov_b32 s20, s36
    s_mov_b32 s21, s37
    s_mov_b32 s22, 5120
    s_mov_b32 s23, 0x20000
    buffer_load_dword v14, v10, s[20:23], s64 offen offset:0
    buffer_load_dword v15, v10, s[20:23], s64 offen offset:256
    buffer_load_dword v16, v10, s[20:23], s64 offen offset:512
    buffer_load_dword v17, v10, s[20:23], s64 offen offset:768
    buffer_load_dword v18, v10, s[20:23], s64 offen offset:1024
    buffer_load_dword v48, v10, s[20:23], s61 offen offset:0
    buffer_load_dword v49, v10, s[20:23], s61 offen offset:256
    buffer_load_dword v50, v10, s[20:23], s61 offen offset:512
    buffer_load_dword v51, v10, s[20:23], s61 offen offset:768
    buffer_load_dword v52, v10, s[20:23], s61 offen offset:1024
    s_load_dword s74, s[58:59], 0xac000
    s_add_u32 s8, s42, s62
    s_addc_u32 s9, s43, 0
    s_mov_b32 s10, s63
    s_mov_b32 s11, 0x20000
    s_and_b32 s71, s5, 7
    s_mul_i32 s71, s71, 5
    s_lshr_b32 s71, s71, 2
    s_mul_i32 s65, s71, 32768
    buffer_load_dwordx4 v[96:99], v11, s[8:11], s65 offen
    s_add_u32 s65, s65, 8192
    buffer_load_dwordx4 v[100:103], v11, s[8:11], s65 offen
    s_add_u32 s65, s65, 8192
    buffer_load_dwordx4 v[104:107], v11, s[8:11], s65 offen
    s_add_u32 s65, s65, 8192
    buffer_load_dwordx4 v[108:111], v11, s[8:11], s65 offen
    s_add_u32 s65, s65, 8192
    s_cmp_eq_u32 s65, 327680
    s_cselect_b32 s65, 0, s65
    buffer_load_dwordx4 v[112:115], v11, s[8:11], s65 offen
    s_add_u32 s65, s65, 8192
    s_branch L_aux2
L_str:
    s_sub_u32 s3, s3, 4
    v_lshlrev_b32 v18, 8, v9
    v_and_b32 v19, 1, v2
    v_lshl_add_u32 v18, v19, 6, v18
    v_lshl_add_u32 v18, v3, 4, v18
    v_add_u32 v19, 128, v18
    s_lshr_b32 s63, s5, 1
    s_cmp_lt_u32 s63, s95
    s_cselect_b32 s62, 0, 0
    s_add_u32 s62, s62, 256
    s_sub_u32 s63, 512, s62
    s_cmp_eq_u32 s6, 0
    s_cselect_b32 s66, s62, s63
    s_cselect_b32 s65, 0, s62
    s_add_u32 s65, s65, s3
    s_lshl_b32 s65, s65, 12
    s_mov_b32 s70, s65
    s_sub_u32 s66, s66, s3
    s_add_u32 s66, s66, 3
    s_lshr_b32 s66, s66, 2
    s_mov_b32 s71, s66
    s_lshl_b32 s61, s7, 5
    s_add_u32 s61, s61, s60
    s_lshl_b32 s61, s61, 21
    s_waitcnt lgkmcnt(0)
    s_add_u32 s8, s38, s61
    s_addc_u32 s9, s39, 0
    s_mov_b32 s10, 2097152
    s_mov_b32 s11, 0x20000
    s_add_u32 s12, s40, s61
    s_addc_u32 s13, s41, 0
    buffer_load_dwordx4 v[128:131], v18, s[8:11], s65 offen offset:0 nt
    buffer_load_dwordx4 v[132:135], v19, s[8:11], s65 offen offset:0 nt
    buffer_load_dwordx4 v[136:139], v18, s[8:11], s65 offen offset:2048 nt
    buffer_load_dwordx4 v[140:143], v19, s[8:11], s65 offen offset:2048 nt
    s_add_u32 s65, s65, 16384
    s_bfm_b32 s61, s4, 0
    s_and_b32 s61, s61, 0x15
    s_bcnt1_i32_b32 s61, s61
    s_cmp_eq_u32 s3, 0
    s_cbranch_scc1 L_pf_wo
    s_branch L_pf_done
L_pf_wo:
    s_mul_i32 s62, s60, 163840
    s_and_b32 s63, s5, 7
    s_mul_i32 s63, s63, 20480
    s_add_u32 s62, s62, s63
    s_mov_b32 s24, s44
    s_mov_b32 s25, s45
    s_mov_b32 s26, 5242880
    s_mov_b32 s27, 0x20000
    v_lshlrev_b32 v20, 6, v1
    buffer_load_dword v24, v20, s[24:27], s62 offen
    s_add_u32 s62, s62, 4096
    buffer_load_dword v25, v20, s[24:27], s62 offen
    s_add_u32 s62, s62, 4096
    buffer_load_dword v26, v20, s[24:27], s62 offen
    s_add_u32 s62, s62, 4096
    buffer_load_dword v27, v20, s[24:27], s62 offen
    s_add_u32 s62, s62, 4096
    buffer_load_dword v28, v20, s[24:27], s62 offen
    s_add_u32 s62, s62, 4096
    s_branch L_pf_done
L_pf_done:
    s_and_b32 s61, s5, 3
    s_cmp_lg_u32 s61, 0
    s_cbranch_scc1 L_sg0
    s_barrier
    s_barrier
L_sg0:
    buffer_load_dwordx4 v[144:147], v18, s[8:11], s65 offen offset:0 nt
    buffer_load_dwordx4 v[148:151], v19, s[8:11], s65 offen offset:0 nt
    buffer_load_dwordx4 v[152:155], v18, s[8:11], s65 offen offset:2048 nt
    buffer_load_dwordx4 v[156:159], v19, s[8:11], s65 offen offset:2048 nt
    s_add_u32 s65, s65, 16384
    buffer_load_dwordx4 v[160:163], v18, s[8:11], s65 offen offset:0 nt
    buffer_load_dwordx4 v[164:167], v19, s[8:11], s65 offen offset:0 nt
    buffer_load_dwordx4 v[168:171], v18, s[8:11], s65 offen offset:2048 nt
    buffer_load_dwordx4 v[172:175], v19, s[8:11], s65 offen offset:2048 nt
    s_add_u32 s65, s65, 16384
    buffer_load_dwordx4 v[176:179], v18, s[8:11], s65 offen offset:0 nt
    buffer_load_dwordx4 v[180:183], v19, s[8:11], s65 offen offset:0 nt
    buffer_load_dwordx4 v[184:187], v18, s[8:11], s65 offen offset:2048 nt
    buffer_load_dwordx4 v[188:191], v19, s[8:11], s65 offen offset:2048 nt
    s_add_u32 s65, s65, 16384
    buffer_load_dwordx4 v[192:195], v18, s[8:11], s65 offen offset:0 nt
    buffer_load_dwordx4 v[196:199], v19, s[8:11], s65 offen offset:0 nt
    buffer_load_dwordx4 v[200:203], v18, s[8:11], s65 offen offset:2048 nt
    buffer_load_dwordx4 v[204:207], v19, s[8:11], s65 offen offset:2048 nt
    s_add_u32 s65, s65, 16384
    s_and_b32 s61, s5, 3
    s_cmp_lg_u32 s61, 1
    s_cbranch_scc1 L_sg1
    s_barrier
    s_barrier
L_sg1:
    buffer_load_dwordx4 v[208:211], v18, s[8:11], s65 offen offset:0 nt
    buffer_load_dwordx4 v[212:215], v19, s[8:11], s65 offen offset:0 nt
    buffer_load_dwordx4 v[216:219], v18, s[8:11], s65 offen offset:2048 nt
    buffer_load_dwordx4 v[220:223], v19, s[8:11], s65 offen offset:2048 nt
    s_add_u32 s65, s65, 16384
    buffer_load_dwordx4 v[224:227], v18, s[8:11], s65 offen offset:0 nt
    buffer_load_dwordx4 v[228:231], v19, s[8:11], s65 offen offset:0 nt
    buffer_load_dwordx4 v[232:235], v18, s[8:11], s65 offen offset:2048 nt
    buffer_load_dwordx4 v[236:239], v19, s[8:11], s65 offen offset:2048 nt
    s_add_u32 s65, s65, 16384
    buffer_load_dwordx4 v[240:243], v18, s[8:11], s65 offen offset:0 nt
    buffer_load_dwordx4 v[244:247], v19, s[8:11], s65 offen offset:0 nt
    buffer_load_dwordx4 v[248:251], v18, s[8:11], s65 offen offset:2048 nt
    buffer_load_dwordx4 v[252:255], v19, s[8:11], s65 offen offset:2048 nt
    s_add_u32 s65, s65, 16384
    s_and_b32 s61, s5, 3
    s_cmp_lg_u32 s61, 2
    s_cbranch_scc1 L_sg2
    s_barrier
    s_barrier
L_sg2:
    buffer_load_dwordx4 v[64:67], v18, s[8:11], s65 offen offset:0 nt
    buffer_load_dwordx4 v[68:71], v19, s[8:11], s65 offen offset:0 nt
    buffer_load_dwordx4 v[72:75], v18, s[8:11], s65 offen offset:2048 nt
    buffer_load_dwordx4 v[76:79], v19, s[8:11], s65 offen offset:2048 nt
    s_add_u32 s65, s65, 16384
    buffer_load_dwordx4 v[80:83], v18, s[8:11], s65 offen offset:0 nt
    buffer_load_dwordx4 v[84:87], v19, s[8:11], s65 offen offset:0 nt
    buffer_load_dwordx4 v[88:91], v18, s[8:11], s65 offen offset:2048 nt
    buffer_load_dwordx4 v[92:95], v19, s[8:11], s65 offen offset:2048 nt
    s_add_u32 s65, s65, 16384
    buffer_load_dwordx4 v[96:99], v18, s[8:11], s65 offen offset:0 nt
    buffer_load_dwordx4 v[100:103], v19, s[8:11], s65 offen offset:0 nt
    buffer_load_dwordx4 v[104:107], v18, s[8:11], s65 offen offset:2048 nt
    buffer_load_dwordx4 v[108:111], v19, s[8:11], s65 offen offset:2048 nt
    s_add_u32 s65, s65, 16384
    s_and_b32 s61, s5, 3
    s_cmp_lg_u32 s61, 3
    s_cbranch_scc1 L_sg3
    s_barrier
    s_barrier
L_sg3:
    buffer_load_dwordx4 v[112:115], v18, s[8:11], s65 offen offset:0 nt
    buffer_load_dwordx4 v[116:119], v19, s[8:11], s65 offen offset:0 nt
    buffer_load_dwordx4 v[120:123], v18, s[8:11], s65 offen offset:2048 nt
    buffer_load_dwordx4 v[124:127], v19, s[8:11], s65 offen offset:2048 nt
    s_add_u32 s65, s65, 16384
    s_waitcnt vmcnt(44)
    v_cmp_eq_u32 vcc, 4, v9
    s_nop 1
    v_cndmask_b32 v4, 0, v8, vcc
    v_cmp_eq_u32 vcc, 5, v9
    s_nop 1
    v_cndmask_b32 v5, 0, v8, vcc
    v_cmp_eq_u32 vcc, 6, v9
    s_nop 1
    v_cndmask_b32 v6, 0, v8, vcc
    v_cmp_eq_u32 vcc, 7, v9
    s_nop 1
    v_cndmask_b32 v7, 0, v8, vcc
    v_lshlrev_b32 v16, 9, v3
    v_lshl_add_u32 v16, v2, 4, v16
    v_mov_b32 v10, 0xff7fffff
    v_mov_b32 v11, 0
    v_mov_b32 v20, 0
    v_mov_b32 v21, 0
    v_mov_b32 v22, 0
    v_mov_b32 v23, 0
    v_lshlrev_b32 v14, 3, v1
    s_lshl_b32 s61, s3, 8
    s_add_u32 s61, s61, 17408
    v_lshl_add_u32 v15, v1, 2, s61
    v_lshl_add_u32 v17, v3, 4, s61
    v_lshrrev_b32 v12, 3, v2
    v_lshl_add_u32 v17, v12, 6, v17
    s_lshl_b32 s62, s3, 8
    s_add_u32 s62, s62, 18416
    v_lshlrev_b32 v8, 4, v2
    v_lshl_add_u32 v8, v3, 3, v8
    v_add_u32 v8, s62, v8
    s_lshl_b32 s62, s3, 2
    s_add_u32 s62, s62, 19456
    v_mov_b32 v9, s62
    s_mul_i32 s64, s3, 2304
    s_add_u32 s64, s64, 23392
    v_lshl_add_u32 v13, v3, 3, s64
    s_mov_b32 s72, 0x80008000
    s_mov_b32 s73, 0x80008000
    s_barrier
    ds_read_b64 v[48:49], v14 offset:15360
    ds_read_b64 v[50:51], v14 offset:15872
    ds_read_b64 v[52:53], v14 offset:16384
    ds_read_b64 v[54:55], v14 offset:16896
    s_waitcnt lgkmcnt(0)
    v_add_f32 v48, v48, v50
    v_add_f32 v49, v49, v51
    v_add_f32 v48, v48, v52
    v_add_f32 v49, v49, v53
    v_add_f32 v48, v48, v54
    v_add_f32 v49, v49, v55
    v_cvt_pk_bf16_f32 v48, v48, v49
    ds_write_b32 v15, v48
    s_waitcnt lgkmcnt(0)
    ds_read_b128 v[32:35], v17 offset:0
    ds_read_b128 v[36:39], v17 offset:128
    s_waitcnt lgkmcnt(0)
    v_mov_b32 v0, 1
    v_mov_b32 v1, 0
    s_cmp_eq_u32 s3, 0
    s_cselect_b32 s62, 0, 8
    v_mov_b32 v2, s62
    s_waitcnt vmcnt(12)
    v_mfma_f32_16x16x32_bf16 v[40:43], v[64:67], v[32:35], 0
    v_mfma_f32_16x16x32_bf16 v[44:47], v[72:75], v[32:35], 0
    v_mfma_f32_16x16x32_bf16 v[40:43], v[68:71], v[36:39], v[40:43]
    v_mfma_f32_16x16x32_bf16 v[44:47], v[76:79], v[36:39], v[44:47]
    s_waitcnt vmcnt(5)
    buffer_load_dwordx4 v[64:67], v18, s[8:11], s65 offen offset:0 nt
    s_waitcnt vmcnt(5)
    buffer_load_dwordx4 v[68:71], v19, s[8:11], s65 offen offset:0 nt
    s_waitcnt vmcnt(5)
    buffer_load_dwordx4 v[72:75], v18, s[8:11], s65 offen offset:2048 nt
    s_waitcnt vmcnt(5)
    buffer_load_dwordx4 v[76:79], v19, s[8:11], s65 offen offset:2048 nt
    s_add_u32 s65, s65, 16384
    v_add_f32_dpp v24, v40, v41 row_ror:8 row_mask:0xf bank_mask:0xf
    v_add_f32_dpp v25, v42, v43 row_ror:8 row_mask:0xf bank_mask:0xf
    v_add_f32_dpp v26, v44, v45 row_ror:8 row_mask:0xf bank_mask:0xf
    v_add_f32_dpp v27, v46, v47 row_ror:8 row_mask:0xf bank_mask:0xf
    v_cvt_pk_bf16_f32 v14, v24, v25
    v_cvt_pk_bf16_f32 v15, v26, v27
    v_max3_f32 v10, v24, v25, v10
    v_lshlrev_b32 v28, 16, v14
    v_and_b32 v29, 0xffff0000, v14
    v_lshlrev_b32 v30, 16, v15
    v_and_b32 v31, 0xffff0000, v15
    v_max3_f32 v10, v26, v27, v10
    v_mul_f32 v28, s69, v28
    v_mul_f32 v29, s69, v29
    v_mul_f32 v30, s69, v30
    v_mul_f32 v31, s69, v31
    v_cvt_pk_bf16_f32 v14, v28, v29
    v_cvt_pk_bf16_f32 v15, v30, v31
    s_mov_b64 exec, s[72:73]
    ds_write_b64 v13, v[14:15] offset:256
    s_mov_b64 exec, -1
    v_mfma_f32_16x16x32_bf16 v[40:43], v[128:131], v[32:35], 0
    v_mfma_f32_16x16x32_bf16 v[44:47], v[136:139], v[32:35], 0
    v_mfma_f32_16x16x32_bf16 v[40:43], v[132:135], v[36:39], v[40:43]
    v_mfma_f32_16x16x32_bf16 v[44:47], v[140:143], v[36:39], v[44:47]
    s_nop 7
    v_add_f32_dpp v24, v40, v41 row_ror:8 row_mask:0xf bank_mask:0xf
    v_add_f32_dpp v25, v42, v43 row_ror:8 row_mask:0xf bank_mask:0xf
    v_add_f32_dpp v26, v44, v45 row_ror:8 row_mask:0xf bank_mask:0xf
    v_add_f32_dpp v27, v46, v47 row_ror:8 row_mask:0xf bank_mask:0xf
    v_cvt_pk_bf16_f32 v14, v24, v25
    v_cvt_pk_bf16_f32 v15, v26, v27
    v_max3_f32 v10, v24, v25, v10
    v_lshlrev_b32 v28, 16, v14
    v_and_b32 v29, 0xffff0000, v14
    v_lshlrev_b32 v30, 16, v15
    v_and_b32 v31, 0xffff0000, v15
    v_max3_f32 v10, v26, v27, v10
    v_mul_f32 v28, s69, v28
    v_mul_f32 v29, s69, v29
    v_mul_f32 v30, s69, v30
    v_mul_f32 v31, s69, v31
    v_cvt_pk_bf16_f32 v14, v28, v29
    v_cvt_pk_bf16_f32 v15, v30, v31
    s_mov_b64 exec, s[72:73]
    ds_write_b64 v13, v[14:15] offset:0
    s_mov_b64 exec, -1
    v_mfma_f32_16x16x32_bf16 v[40:43], v[144:147], v[32:35], 0
    v_mfma_f32_16x16x32_bf16 v[44:47], v[152:155], v[32:35], 0
    v_mfma_f32_16x16x32_bf16 v[40:43], v[148:151], v[36:39], v[40:43]
    v_mfma_f32_16x16x32_bf16 v[44:47], v[156:159], v[36:39], v[44:47]
    s_nop 7
    v_add_f32_dpp v24, v40, v41 row_ror:8 row_mask:0xf bank_mask:0xf
    v_add_f32_dpp v25, v42, v43 row_ror:8 row_mask:0xf bank_mask:0xf
    v_add_f32_dpp v26, v44, v45 row_ror:8 row_mask:0xf bank_mask:0xf
    v_add_f32_dpp v27, v46, v47 row_ror:8 row_mask:0xf bank_mask:0xf
    v_cvt_pk_bf16_f32 v14, v24, v25
    v_cvt_pk_bf16_f32 v15, v26, v27
    v_max3_f32 v10, v24, v25, v10
    v_lshlrev_b32 v28, 16, v14
    v_and_b32 v29, 0xffff0000, v14
    v_lshlrev_b32 v30, 16, v15
    v_and_b32 v31, 0xffff0000, v15
    v_max3_f32 v10, v26, v27, v10
    v_mul_f32 v28, s69, v28
    v_mul_f32 v29, s69, v29
    v_mul_f32 v30, s69, v30
    v_mul_f32 v31, s69, v31
    v_cvt_pk_bf16_f32 v14, v28, v29
    v_cvt_pk_bf16_f32 v15, v30, v31
    s_mov_b64 exec, s[72:73]
    ds_write_b64 v13, v[14:15] offset:32
    s_mov_b64 exec, -1
    s_waitcnt vmcnt(12)
    v_mfma_f32_16x16x32_bf16 v[40:43], v[80:83], v[32:35], 0
    v_mfma_f32_16x16x32_bf16 v[44:47], v[88:91], v[32:35], 0
    v_mfma_f32_16x16x32_bf16 v[40:43], v[84:87], v[36:39], v[40:43]
    v_mfma_f32_16x16x32_bf16 v[44:47], v[92:95], v[36:39], v[44:47]
    s_waitcnt vmcnt(4)
    buffer_load_dwordx4 v[80:83], v18, s[8:11], s65 offen offset:0 nt
    s_waitcnt vmcnt(4)
    buffer_load_dwordx4 v[84:87], v19, s[8:11], s65 offen offset:0 nt
    s_waitcnt vmcnt(4)
    buffer_load_dwordx4 v[88:91], v18, s[8:11], s65 offen offset:2048 nt
    s_waitcnt vmcnt(4)
    buffer_load_dwordx4 v[92:95], v19, s[8:11], s65 offen offset:2048 nt
    s_add_u32 s65, s65, 16384
    v_add_f32_dpp v24, v40, v41 row_ror:8 row_mask:0xf bank_mask:0xf
    v_add_f32_dpp v25, v42, v43 row_ror:8 row_mask:0xf bank_mask:0xf
    v_add_f32_dpp v26, v44, v45 row_ror:8 row_mask:0xf bank_mask:0xf
    v_add_f32_dpp v27, v46, v47 row_ror:8 row_mask:0xf bank_mask:0xf
    v_cvt_pk_bf16_f32 v14, v24, v25
    v_cvt_pk_bf16_f32 v15, v26, v27
    v_max3_f32 v10, v24, v25, v10
    v_lshlrev_b32 v28, 16, v14
    v_and_b32 v29, 0xffff0000, v14
    v_lshlrev_b32 v30, 16, v15
    v_and_b32 v31, 0xffff0000, v15
    v_max3_f32 v10, v26, v27, v10
    v_mul_f32 v28, s69, v28
    v_mul_f32 v29, s69, v29
    v_mul_f32 v30, s69, v30
    v_mul_f32 v31, s69, v31
    v_cvt_pk_bf16_f32 v14, v28, v29
    v_cvt_pk_bf16_f32 v15, v30, v31
    s_mov_b64 exec, s[72:73]
    ds_write_b64 v13, v[14:15] offset:288
    s_mov_b64 exec, -1
    v_mfma_f32_16x16x32_bf16 v[40:43], v[160:163], v[32:35], 0
    v_mfma_f32_16x16x32_bf16 v[44:47], v[168:171], v[32:35], 0
    v_mfma_f32_16x16x32_bf16 v[40:43], v[164:167], v[36:39], v[40:43]
    v_mfma_f32_16x16x32_bf16 v[44:47], v[172:175], v[36:39], v[44:47]
    s_nop 7
    v_add_f32_dpp v24, v40, v41 row_ror:8 row_mask:0xf bank_mask:0xf
    v_add_f32_dpp v25, v42, v43 row_ror:8 row_mask:0xf bank_mask:0xf
    v_add_f32_dpp v26, v44, v45 row_ror:8 row_mask:0xf bank_mask:0xf
    v_add_f32_dpp v27, v46, v47 row_ror:8 row_mask:0xf bank_mask:0xf
    v_cvt_pk_bf16_f32 v14, v24, v25
    v_cvt_pk_bf16_f32 v15, v26, v27
    v_max3_f32 v10, v24, v25, v10
    v_lshlrev_b32 v28, 16, v14
    v_and_b32 v29, 0xffff0000, v14
    v_lshlrev_b32 v30, 16, v15
    v_and_b32 v31, 0xffff0000, v15
    v_max3_f32 v10, v26, v27, v10
    v_mul_f32 v28, s69, v28
    v_mul_f32 v29, s69, v29
    v_mul_f32 v30, s69, v30
    v_mul_f32 v31, s69, v31
    v_cvt_pk_bf16_f32 v14, v28, v29
    v_cvt_pk_bf16_f32 v15, v30, v31
    s_mov_b64 exec, s[72:73]
    ds_write_b64 v13, v[14:15] offset:64
    s_mov_b64 exec, -1
    v_mfma_f32_16x16x32_bf16 v[40:43], v[176:179], v[32:35], 0
    v_mfma_f32_16x16x32_bf16 v[44:47], v[184:187], v[32:35], 0
    v_mfma_f32_16x16x32_bf16 v[40:43], v[180:183], v[36:39], v[40:43]
    v_mfma_f32_16x16x32_bf16 v[44:47], v[188:191], v[36:39], v[44:47]
    s_nop 7
    v_add_f32_dpp v24, v40, v41 row_ror:8 row_mask:0xf bank_mask:0xf
    v_add_f32_dpp v25, v42, v43 row_ror:8 row_mask:0xf bank_mask:0xf
    v_add_f32_dpp v26, v44, v45 row_ror:8 row_mask:0xf bank_mask:0xf
    v_add_f32_dpp v27, v46, v47 row_ror:8 row_mask:0xf bank_mask:0xf
    v_cvt_pk_bf16_f32 v14, v24, v25
    v_cvt_pk_bf16_f32 v15, v26, v27
    v_max3_f32 v10, v24, v25, v10
    v_lshlrev_b32 v28, 16, v14
    v_and_b32 v29, 0xffff0000, v14
    v_lshlrev_b32 v30, 16, v15
    v_and_b32 v31, 0xffff0000, v15
    v_max3_f32 v10, v26, v27, v10
    v_mul_f32 v28, s69, v28
    v_mul_f32 v29, s69, v29
    v_mul_f32 v30, s69, v30
    v_mul_f32 v31, s69, v31
    v_cvt_pk_bf16_f32 v14, v28, v29
    v_cvt_pk_bf16_f32 v15, v30, v31
    s_mov_b64 exec, s[72:73]
    ds_write_b64 v13, v[14:15] offset:96
    s_mov_b64 exec, -1
    s_waitcnt vmcnt(12)
    v_mfma_f32_16x16x32_bf16 v[40:43], v[96:99], v[32:35], 0
    v_mfma_f32_16x16x32_bf16 v[44:47], v[104:107], v[32:35], 0
    v_mfma_f32_16x16x32_bf16 v[40:43], v[100:103], v[36:39], v[40:43]
    v_mfma_f32_16x16x32_bf16 v[44:47], v[108:111], v[36:39], v[44:47]
    s_waitcnt vmcnt(5)
    buffer_load_dwordx4 v[96:99], v18, s[8:11], s65 offen offset:0 nt
    s_waitcnt vmcnt(5)
    buffer_load_dwordx4 v[100:103], v19, s[8:11], s65 offen offset:0 nt
    s_waitcnt vmcnt(5)
    buffer_load_dwordx4 v[104:107], v18, s[8:11], s65 offen offset:2048 nt
    s_waitcnt vmcnt(5)
    buffer_load_dwordx4 v[108:111], v19, s[8:11], s65 offen offset:2048 nt
    s_add_u32 s65, s65, 16384
    v_add_f32_dpp v24, v40, v41 row_ror:8 row_mask:0xf bank_mask:0xf
    v_add_f32_dpp v25, v42, v43 row_ror:8 row_mask:0xf bank_mask:0xf
    v_add_f32_dpp v26, v44, v45 row_ror:8 row_mask:0xf bank_mask:0xf
    v_add_f32_dpp v27, v46, v47 row_ror:8 row_mask:0xf bank_mask:0xf
    v_cvt_pk_bf16_f32 v14, v24, v25
    v_cvt_pk_bf16_f32 v15, v26, v27
    v_max3_f32 v10, v24, v25, v10
    v_lshlrev_b32 v28, 16, v14
    v_and_b32 v29, 0xffff0000, v14
    v_lshlrev_b32 v30, 16, v15
    v_and_b32 v31, 0xffff0000, v15
    v_max3_f32 v10, v26, v27, v10
    v_mul_f32 v28, s69, v28
    v_mul_f32 v29, s69, v29
    v_mul_f32 v30, s69, v30
    v_mul_f32 v31, s69, v31
    v_cvt_pk_bf16_f32 v14, v28, v29
    v_cvt_pk_bf16_f32 v15, v30, v31
    s_mov_b64 exec, s[72:73]
    ds_write_b64 v13, v[14:15] offset:320
    s_mov_b64 exec, -1
    v_mfma_f32_16x16x32_bf16 v[40:43], v[192:195], v[32:35], 0
    v_mfma_f32_16x16x32_bf16 v[44:47], v[200:203], v[32:35], 0
    v_mfma_f32_16x16x32_bf16 v[40:43], v[196:199], v[36:39], v[40:43]
    v_mfma_f32_16x16x32_bf16 v[44:47], v[204:207], v[36:39], v[44:47]
    s_nop 7
    v_add_f32_dpp v24, v40, v41 row_ror:8 row_mask:0xf bank_mask:0xf
    v_add_f32_dpp v25, v42, v43 row_ror:8 row_mask:0xf bank_mask:0xf
    v_add_f32_dpp v26, v44, v45 row_ror:8 row_mask:0xf bank_mask:0xf
    v_add_f32_dpp v27, v46, v47 row_ror:8 row_mask:0xf bank_mask:0xf
    v_cvt_pk_bf16_f32 v14, v24, v25
    v_cvt_pk_bf16_f32 v15, v26, v27
    v_max3_f32 v10, v24, v25, v10
    v_lshlrev_b32 v28, 16, v14
    v_and_b32 v29, 0xffff0000, v14
    v_lshlrev_b32 v30, 16, v15
    v_and_b32 v31, 0xffff0000, v15
    v_max3_f32 v10, v26, v27, v10
    v_mul_f32 v28, s69, v28
    v_mul_f32 v29, s69, v29
    v_mul_f32 v30, s69, v30
    v_mul_f32 v31, s69, v31
    v_cvt_pk_bf16_f32 v14, v28, v29
    v_cvt_pk_bf16_f32 v15, v30, v31
    s_mov_b64 exec, s[72:73]
    ds_write_b64 v13, v[14:15] offset:128
    s_mov_b64 exec, -1
    v_mfma_f32_16x16x32_bf16 v[40:43], v[208:211], v[32:35], 0
    v_mfma_f32_16x16x32_bf16 v[44:47], v[216:219], v[32:35], 0
    v_mfma_f32_16x16x32_bf16 v[40:43], v[212:215], v[36:39], v[40:43]
    v_mfma_f32_16x16x32_bf16 v[44:47], v[220:223], v[36:39], v[44:47]
    s_nop 7
    v_add_f32_dpp v24, v40, v41 row_ror:8 row_mask:0xf bank_mask:0xf
    v_add_f32_dpp v25, v42, v43 row_ror:8 row_mask:0xf bank_mask:0xf
    v_add_f32_dpp v26, v44, v45 row_ror:8 row_mask:0xf bank_mask:0xf
    v_add_f32_dpp v27, v46, v47 row_ror:8 row_mask:0xf bank_mask:0xf
    v_cvt_pk_bf16_f32 v14, v24, v25
    v_cvt_pk_bf16_f32 v15, v26, v27
    v_max3_f32 v10, v24, v25, v10
    v_lshlrev_b32 v28, 16, v14
    v_and_b32 v29, 0xffff0000, v14
    v_lshlrev_b32 v30, 16, v15
    v_and_b32 v31, 0xffff0000, v15
    v_max3_f32 v10, v26, v27, v10
    v_mul_f32 v28, s69, v28
    v_mul_f32 v29, s69, v29
    v_mul_f32 v30, s69, v30
    v_mul_f32 v31, s69, v31
    v_cvt_pk_bf16_f32 v14, v28, v29
    v_cvt_pk_bf16_f32 v15, v30, v31
    s_mov_b64 exec, s[72:73]
    ds_write_b64 v13, v[14:15] offset:160
    s_mov_b64 exec, -1
    s_waitcnt vmcnt(12)
    v_mfma_f32_16x16x32_bf16 v[40:43], v[112:115], v[32:35], 0
    v_mfma_f32_16x16x32_bf16 v[44:47], v[120:123], v[32:35], 0
    v_mfma_f32_16x16x32_bf16 v[40:43], v[116:119], v[36:39], v[40:43]
    v_mfma_f32_16x16x32_bf16 v[44:47], v[124:127], v[36:39], v[44:47]
    s_waitcnt vmcnt(4)
    buffer_load_dwordx4 v[112:115], v18, s[8:11], s65 offen offset:0 nt
    s_waitcnt vmcnt(4)
    buffer_load_dwordx4 v[116:119], v19, s[8:11], s65 offen offset:0 nt
    s_waitcnt vmcnt(4)
    buffer_load_dwordx4 v[120:123], v18, s[8:11], s65 offen offset:2048 nt
    s_waitcnt vmcnt(4)
    buffer_load_dwordx4 v[124:127], v19, s[8:11], s65 offen offset:2048 nt
    s_add_u32 s65, s65, 16384
    v_add_f32_dpp v24, v40, v41 row_ror:8 row_mask:0xf bank_mask:0xf
    v_add_f32_dpp v25, v42, v43 row_ror:8 row_mask:0xf bank_mask:0xf
    v_add_f32_dpp v26, v44, v45 row_ror:8 row_mask:0xf bank_mask:0xf
    v_add_f32_dpp v27, v46, v47 row_ror:8 row_mask:0xf bank_mask:0xf
    v_cvt_pk_bf16_f32 v14, v24, v25
    v_cvt_pk_bf16_f32 v15, v26, v27
    v_max3_f32 v10, v24, v25, v10
    v_lshlrev_b32 v28, 16, v14
    v_and_b32 v29, 0xffff0000, v14
    v_lshlrev_b32 v30, 16, v15
    v_and_b32 v31, 0xffff0000, v15
    v_max3_f32 v10, v26, v27, v10
    v_mul_f32 v28, s69, v28
    v_mul_f32 v29, s69, v29
    v_mul_f32 v30, s69, v30
    v_mul_f32 v31, s69, v31
    v_cvt_pk_bf16_f32 v14, v28, v29
    v_cvt_pk_bf16_f32 v15, v30, v31
    s_mov_b64 exec, s[72:73]
    ds_write_b64 v13, v[14:15] offset:352
    s_mov_b64 exec, -1
    v_mfma_f32_16x16x32_bf16 v[40:43], v[224:227], v[32:35], 0
    v_mfma_f32_16x16x32_bf16 v[44:47], v[232:235], v[32:35], 0
    v_mfma_f32_16x16x32_bf16 v[40:43], v[228:231], v[36:39], v[40:43]
    v_mfma_f32_16x16x32_bf16 v[44:47], v[236:239], v[36:39], v[44:47]
    s_nop 7
    v_add_f32_dpp v24, v40, v41 row_ror:8 row_mask:0xf bank_mask:0xf
    v_add_f32_dpp v25, v42, v43 row_ror:8 row_mask:0xf bank_mask:0xf
    v_add_f32_dpp v26, v44, v45 row_ror:8 row_mask:0xf bank_mask:0xf
    v_add_f32_dpp v27, v46, v47 row_ror:8 row_mask:0xf bank_mask:0xf
    v_cvt_pk_bf16_f32 v14, v24, v25
    v_cvt_pk_bf16_f32 v15, v26, v27
    v_max3_f32 v10, v24, v25, v10
    v_lshlrev_b32 v28, 16, v14
    v_and_b32 v29, 0xffff0000, v14
    v_lshlrev_b32 v30, 16, v15
    v_and_b32 v31, 0xffff0000, v15
    v_max3_f32 v10, v26, v27, v10
    v_mul_f32 v28, s69, v28
    v_mul_f32 v29, s69, v29
    v_mul_f32 v30, s69, v30
    v_mul_f32 v31, s69, v31
    v_cvt_pk_bf16_f32 v14, v28, v29
    v_cvt_pk_bf16_f32 v15, v30, v31
    s_mov_b64 exec, s[72:73]
    ds_write_b64 v13, v[14:15] offset:192
    s_mov_b64 exec, -1
    v_mfma_f32_16x16x32_bf16 v[40:43], v[240:243], v[32:35], 0
    v_mfma_f32_16x16x32_bf16 v[44:47], v[248:251], v[32:35], 0
    v_mfma_f32_16x16x32_bf16 v[40:43], v[244:247], v[36:39], v[40:43]
    v_mfma_f32_16x16x32_bf16 v[44:47], v[252:255], v[36:39], v[44:47]
    s_nop 7
    v_add_f32_dpp v24, v40, v41 row_ror:8 row_mask:0xf bank_mask:0xf
    v_add_f32_dpp v25, v42, v43 row_ror:8 row_mask:0xf bank_mask:0xf
    v_add_f32_dpp v26, v44, v45 row_ror:8 row_mask:0xf bank_mask:0xf
    v_add_f32_dpp v27, v46, v47 row_ror:8 row_mask:0xf bank_mask:0xf
    v_cvt_pk_bf16_f32 v14, v24, v25
    v_cvt_pk_bf16_f32 v15, v26, v27
    v_max3_f32 v10, v24, v25, v10
    v_lshlrev_b32 v28, 16, v14
    v_and_b32 v29, 0xffff0000, v14
    v_lshlrev_b32 v30, 16, v15
    v_and_b32 v31, 0xffff0000, v15
    v_max3_f32 v10, v26, v27, v10
    v_mul_f32 v28, s69, v28
    v_mul_f32 v29, s69, v29
    v_mul_f32 v30, s69, v30
    v_mul_f32 v31, s69, v31
    v_cvt_pk_bf16_f32 v14, v28, v29
    v_cvt_pk_bf16_f32 v15, v30, v31
    s_mov_b64 exec, s[72:73]
    ds_write_b64 v13, v[14:15] offset:224
    s_mov_b64 exec, -1
    v_add_u32 v13, 384, v13
    s_sub_u32 s66, s66, 12
L_k0:
    s_cmp_lg_u32 s66, 4
    s_cbranch_scc1 L_kk0
    s_mov_b32 s8, s12
    s_mov_b32 s9, s13
    s_mov_b32 s65, s70
    v_mov_b32 v18, v16
    v_add_u32 v19, 256, v16
L_kk0:
    s_waitcnt lgkmcnt(0)
    v_readfirstlane_b32 s63, v0
    s_add_u32 s62, s66, s71
    v_mov_b32 v28, s62
    ds_read_b32 v0, v1 offset:19540
    ds_write_b32 v2, v28 offset:19536
    s_waitcnt vmcnt(12)
    v_mfma_f32_16x16x32_bf16 v[40:43], v[64:67], v[32:35], 0
    v_mfma_f32_16x16x32_bf16 v[44:47], v[72:75], v[32:35], 0
    v_mfma_f32_16x16x32_bf16 v[40:43], v[68:71], v[36:39], v[40:43]
    v_mfma_f32_16x16x32_bf16 v[44:47], v[76:79], v[36:39], v[44:47]
    s_cmp_lg_u32 s63, 0
    s_cbranch_scc1 L_km0_0
    s_waitcnt vmcnt(4)
    buffer_load_dwordx4 v[64:67], v18, s[8:11], s65 offen offset:0 nt
    s_waitcnt vmcnt(4)
    buffer_load_dwordx4 v[68:71], v19, s[8:11], s65 offen offset:0 nt
    s_waitcnt vmcnt(4)
    buffer_load_dwordx4 v[72:75], v18, s[8:11], s65 offen offset:2048 nt
    s_waitcnt vmcnt(4)
    buffer_load_dwordx4 v[76:79], v19, s[8:11], s65 offen offset:2048 nt
    s_add_u32 s65, s65, 16384
    s_branch L_kd0
L_km0_0:
    s_cmp_lg_u32 s63, 1
    s_cbranch_scc1 L_km0_1
    s_waitcnt vmcnt(5)
    buffer_load_dwordx4 v[64:67], v18, s[8:11], s65 offen offset:0 nt
    s_waitcnt vmcnt(5)
    buffer_load_dwordx4 v[68:71], v19, s[8:11], s65 offen offset:0 nt
    s_waitcnt vmcnt(5)
    buffer_load_dwordx4 v[72:75], v18, s[8:11], s65 offen offset:2048 nt
    s_waitcnt vmcnt(5)
    buffer_load_dwordx4 v[76:79], v19, s[8:11], s65 offen offset:2048 nt
    s_add_u32 s65, s65, 16384
    s_branch L_kd0
L_km0_1:
    s_cmp_lg_u32 s63, 2
    s_cbranch_scc1 L_km0_2
    s_waitcnt vmcnt(5)
    buffer_load_dwordx4 v[64:67], v18, s[8:11], s65 offen offset:0 nt
    s_waitcnt vmcnt(5)
    buffer_load_dwordx4 v[68:71], v19, s[8:11], s65 offen offset:0 nt
    s_waitcnt vmcnt(5)
    buffer_load_dwordx4 v[72:75], v18, s[8:11], s65 offen offset:2048 nt
    s_waitcnt vmcnt(5)
    buffer_load_dwordx4 v[76:79], v19, s[8:11], s65 offen offset:2048 nt
    s_add_u32 s65, s65, 16384
    s_branch L_kd0
L_km0_2:
    s_cmp_lg_u32 s63, 3
    s_cbranch_scc1 L_km0_3
    s_waitcnt vmcnt(6)
    buffer_load_dwordx4 v[64:67], v18, s[8:11], s65 offen offset:0 nt
    s_waitcnt vmcnt(6)
    buffer_load_dwordx4 v[68:71], v19, s[8:11], s65 offen offset:0 nt
    s_waitcnt vmcnt(6)
    buffer_load_dwordx4 v[72:75], v18, s[8:11], s65 offen offset:2048 nt
    s_waitcnt vmcnt(6)
    buffer_load_dwordx4 v[76:79], v19, s[8:11], s65 offen offset:2048 nt
    s_add_u32 s65, s65, 16384
    s_branch L_kd0
L_km0_3:
    s_cmp_lg_u32 s63, 4
    s_cbranch_scc1 L_km0_4
    s_waitcnt vmcnt(8)
    buffer_load_dwordx4 v[64:67], v18, s[8:11], s65 offen offset:0 nt
    s_waitcnt vmcnt(8)
    buffer_load_dwordx4 v[68:71], v19, s[8:11], s65 offen offset:0 nt
    s_waitcnt vmcnt(8)
    buffer_load_dwordx4 v[72:75], v18, s[8:11], s65 offen offset:2048 nt
    s_waitcnt vmcnt(8)
    buffer_load_dwordx4 v[76:79], v19, s[8:11], s65 offen offset:2048 nt
    s_add_u32 s65, s65, 16384
    s_branch L_kd0
L_km0_4:
    s_waitcnt vmcnt(15)
    buffer_load_dwordx4 v[64:67], v18, s[8:11], s65 offen offset:0 nt
    s_waitcnt vmcnt(15)
    buffer_load_dwordx4 v[68:71], v19, s[8:11], s65 offen offset:0 nt
    s_waitcnt vmcnt(15)
    buffer_load_dwordx4 v[72:75], v18, s[8:11], s65 offen offset:2048 nt
    s_waitcnt vmcnt(15)
    buffer_load_dwordx4 v[76:79], v19, s[8:11], s65 offen offset:2048 nt
    s_add_u32 s65, s65, 16384
L_kd0:
    v_add_f32_dpp v24, v40, v41 row_ror:8 row_mask:0xf bank_mask:0xf
    v_add_f32_dpp v25, v42, v43 row_ror:8 row_mask:0xf bank_mask:0xf
    v_add_f32_dpp v26, v44, v45 row_ror:8 row_mask:0xf bank_mask:0xf
    v_add_f32_dpp v27, v46, v47 row_ror:8 row_mask:0xf bank_mask:0xf
    v_cvt_pk_bf16_f32 v14, v24, v25
    v_cvt_pk_bf16_f32 v15, v26, v27
    v_max3_f32 v10, v24, v25, v10
    v_lshlrev_b32 v28, 16, v14
    v_and_b32 v29, 0xffff0000, v14
    v_lshlrev_b32 v30, 16, v15
    v_and_b32 v31, 0xffff0000, v15
    v_max3_f32 v10, v26, v27, v10
    v_mul_f32 v28, s69, v28
    v_mul_f32 v29, s69, v29
    v_mul_f32 v30, s69, v30
    v_mul_f32 v31, s69, v31
    v_cvt_pk_bf16_f32 v14, v28, v29
    v_cvt_pk_bf16_f32 v15, v30, v31
    s_mov_b64 exec, s[72:73]
    ds_write_b64 v13, v[14:15] offset:0
    s_mov_b64 exec, -1
    v_add_u32 v13, 32, v13
    s_sub_u32 s66, s66, 1
    s_cmp_eq_u32 s66, 0
    s_cbranch_scc1 L_t1
L_k1:
    s_cmp_lg_u32 s66, 4
    s_cbranch_scc1 L_kk1
    s_mov_b32 s8, s12
    s_mov_b32 s9, s13
    s_mov_b32 s65, s70
    v_mov_b32 v18, v16
    v_add_u32 v19, 256, v16
L_kk1:
    s_waitcnt lgkmcnt(0)
    v_readfirstlane_b32 s63, v0
    s_add_u32 s62, s66, s71
    v_mov_b32 v28, s62
    ds_read_b32 v0, v1 offset:19540
    ds_write_b32 v2, v28 offset:19536
    s_waitcnt vmcnt(12)
    v_mfma_f32_16x16x32_bf16 v[40:43], v[80:83], v[32:35], 0
    v_mfma_f32_16x16x32_bf16 v[44:47], v[88:91], v[32:35], 0
    v_mfma_f32_16x16x32_bf16 v[40:43], v[84:87], v[36:39], v[40:43]
    v_mfma_f32_16x16x32_bf16 v[44:47], v[92:95], v[36:39], v[44:47]
    s_cmp_lg_u32 s63, 0
    s_cbranch_scc1 L_km1_0
    s_waitcnt vmcnt(4)
    buffer_load_dwordx4 v[80:83], v18, s[8:11], s65 offen offset:0 nt
    s_waitcnt vmcnt(4)
    buffer_load_dwordx4 v[84:87], v19, s[8:11], s65 offen offset:0 nt
    s_waitcnt vmcnt(4)
    buffer_load_dwordx4 v[88:91], v18, s[8:11], s65 offen offset:2048 nt
    s_waitcnt vmcnt(4)
    buffer_load_dwordx4 v[92:95], v19, s[8:11], s65 offen offset:2048 nt
    s_add_u32 s65, s65, 16384
    s_branch L_kd1
L_km1_0:
    s_cmp_lg_u32 s63, 1
    s_cbranch_scc1 L_km1_1
    s_waitcnt vmcnt(4)
    buffer_load_dwordx4 v[80:83], v18, s[8:11], s65 offen offset:0 nt
    s_waitcnt vmcnt(4)
    buffer_load_dwordx4 v[84:87], v19, s[8:11], s65 offen offset:0 nt
    s_waitcnt vmcnt(4)
    buffer_load_dwordx4 v[88:91], v18, s[8:11], s65 offen offset:2048 nt
    s_waitcnt vmcnt(4)
    buffer_load_dwordx4 v[92:95], v19, s[8:11], s65 offen offset:2048 nt
    s_add_u32 s65, s65, 16384
    s_branch L_kd1
L_km1_1:
    s_cmp_lg_u32 s63, 2
    s_cbranch_scc1 L_km1_2
    s_waitcnt vmcnt(5)
    buffer_load_dwordx4 v[80:83], v18, s[8:11], s65 offen offset:0 nt
    s_waitcnt vmcnt(5)
    buffer_load_dwordx4 v[84:87], v19, s[8:11], s65 offen offset:0 nt
    s_waitcnt vmcnt(5)
    buffer_load_dwordx4 v[88:91], v18, s[8:11], s65 offen offset:2048 nt
    s_waitcnt vmcnt(5)
    buffer_load_dwordx4 v[92:95], v19, s[8:11], s65 offen offset:2048 nt
    s_add_u32 s65, s65, 16384
    s_branch L_kd1
L_km1_2:
    s_cmp_lg_u32 s63, 3
    s_cbranch_scc1 L_km1_3
    s_waitcnt vmcnt(5)
    buffer_load_dwordx4 v[80:83], v18, s[8:11], s65 offen offset:0 nt
    s_waitcnt vmcnt(5)
    buffer_load_dwordx4 v[84:87], v19, s[8:11], s65 offen offset:0 nt
    s_waitcnt vmcnt(5)
    buffer_load_dwordx4 v[88:91], v18, s[8:11], s65 offen offset:2048 nt
    s_waitcnt vmcnt(5)
    buffer_load_dwordx4 v[92:95], v19, s[8:11], s65 offen offset:2048 nt
    s_add_u32 s65, s65, 16384
    s_branch L_kd1
L_km1_3:
    s_cmp_lg_u32 s63, 4
    s_cbranch_scc1 L_km1_4
    s_waitcnt vmcnt(8)
    buffer_load_dwordx4 v[80:83], v18, s[8:11], s65 offen offset:0 nt
    s_waitcnt vmcnt(8)
    buffer_load_dwordx4 v[84:87], v19, s[8:11], s65 offen offset:0 nt
    s_waitcnt vmcnt(8)
    buffer_load_dwordx4 v[88:91], v18, s[8:11], s65 offen offset:2048 nt
    s_waitcnt vmcnt(8)
    buffer_load_dwordx4 v[92:95], v19, s[8:11], s65 offen offset:2048 nt
    s_add_u32 s65, s65, 16384
    s_branch L_kd1
L_km1_4:
    s_waitcnt vmcnt(15)
    buffer_load_dwordx4 v[80:83], v18, s[8:11], s65 offen offset:0 nt
    s_waitcnt vmcnt(15)
    buffer_load_dwordx4 v[84:87], v19, s[8:11], s65 offen offset:0 nt
    s_waitcnt vmcnt(15)
    buffer_load_dwordx4 v[88:91], v18, s[8:11], s65 offen offset:2048 nt
    s_waitcnt vmcnt(15)
    buffer_load_dwordx4 v[92:95], v19, s[8:11], s65 offen offset:2048 nt
    s_add_u32 s65, s65, 16384
L_kd1:
    v_add_f32_dpp v24, v40, v41 row_ror:8 row_mask:0xf bank_mask:0xf
    v_add_f32_dpp v25, v42, v43 row_ror:8 row_mask:0xf bank_mask:0xf
    v_add_f32_dpp v26, v44, v45 row_ror:8 row_mask:0xf bank_mask:0xf
    v_add_f32_dpp v27, v46, v47 row_ror:8 row_mask:0xf bank_mask:0xf
    v_cvt_pk_bf16_f32 v14, v24, v25
    v_cvt_pk_bf16_f32 v15, v26, v27
    v_max3_f32 v10, v24, v25, v10
    v_lshlrev_b32 v28, 16, v14
    v_and_b32 v29, 0xffff0000, v14
    v_lshlrev_b32 v30, 16, v15
    v_and_b32 v31, 0xffff0000, v15
    v_max3_f32 v10, v26, v27, v10
    v_mul_f32 v28, s69, v28
    v_mul_f32 v29, s69, v29
    v_mul_f32 v30, s69, v30
    v_mul_f32 v31, s69, v31
    v_cvt_pk_bf16_f32 v14, v28, v29
    v_cvt_pk_bf16_f32 v15, v30, v31
    s_mov_b64 exec, s[72:73]
    ds_write_b64 v13, v[14:15] offset:0
    s_mov_b64 exec, -1
    v_add_u32 v13, 32, v13
    s_sub_u32 s66, s66, 1
    s_cmp_eq_u32 s66, 0
    s_cbranch_scc1 L_t2
L_k2:
    s_cmp_lg_u32 s66, 4
    s_cbranch_scc1 L_kk2
    s_mov_b32 s8, s12
    s_mov_b32 s9, s13
    s_mov_b32 s65, s70
    v_mov_b32 v18, v16
    v_add_u32 v19, 256, v16
L_kk2:
    s_waitcnt lgkmcnt(0)
    v_readfirstlane_b32 s63, v0
    s_add_u32 s62, s66, s71
    v_mov_b32 v28, s62
    ds_read_b32 v0, v1 offset:19540
    ds_write_b32 v2, v28 offset:19536
    s_waitcnt vmcnt(12)
    v_mfma_f32_16x16x32_bf16 v[40:43], v[96:99], v[32:35], 0
    v_mfma_f32_16x16x32_bf16 v[44:47], v[104:107], v[32:35], 0
    v_mfma_f32_16x16x32_bf16 v[40:43], v[100:103], v[36:39], v[40:43]
    v_mfma_f32_16x16x32_bf16 v[44:47], v[108:111], v[36:39], v[44:47]
    s_cmp_lg_u32 s63, 0
    s_cbranch_scc1 L_km2_0
    s_waitcnt vmcnt(4)
    buffer_load_dwordx4 v[96:99], v18, s[8:11], s65 offen offset:0 nt
    s_waitcnt vmcnt(4)
    buffer_load_dwordx4 v[100:103], v19, s[8:11], s65 offen offset:0 nt
    s_waitcnt vmcnt(4)
    buffer_load_dwordx4 v[104:107], v18, s[8:11], s65 offen offset:2048 nt
    s_waitcnt vmcnt(4)
    buffer_load_dwordx4 v[108:111], v19, s[8:11], s65 offen offset:2048 nt
    s_add_u32 s65, s65, 16384
    s_branch L_kd2
L_km2_0:
    s_cmp_lg_u32 s63, 1
    s_cbranch_scc1 L_km2_1
    s_waitcnt vmcnt(5)
    buffer_load_dwordx4 v[96:99], v18, s[8:11], s65 offen offset:0 nt
    s_waitcnt vmcnt(5)
    buffer_load_dwordx4 v[100:103], v19, s[8:11], s65 offen offset:0 nt
    s_waitcnt vmcnt(5)
    buffer_load_dwordx4 v[104:107], v18, s[8:11], s65 offen offset:2048 nt
    s_waitcnt vmcnt(5)
    buffer_load_dwordx4 v[108:111], v19, s[8:11], s65 offen offset:2048 nt
    s_add_u32 s65, s65, 16384
    s_branch L_kd2
L_km2_1:
    s_cmp_lg_u32 s63, 2
    s_cbranch_scc1 L_km2_2
    s_waitcnt vmcnt(5)
    buffer_load_dwordx4 v[96:99], v18, s[8:11], s65 offen offset:0 nt
    s_waitcnt vmcnt(5)
    buffer_load_dwordx4 v[100:103], v19, s[8:11], s65 offen offset:0 nt
    s_waitcnt vmcnt(5)
    buffer_load_dwordx4 v[104:107], v18, s[8:11], s65 offen offset:2048 nt
    s_waitcnt vmcnt(5)
    buffer_load_dwordx4 v[108:111], v19, s[8:11], s65 offen offset:2048 nt
    s_add_u32 s65, s65, 16384
    s_branch L_kd2
L_km2_2:
    s_cmp_lg_u32 s63, 3
    s_cbranch_scc1 L_km2_3
    s_waitcnt vmcnt(6)
    buffer_load_dwordx4 v[96:99], v18, s[8:11], s65 offen offset:0 nt
    s_waitcnt vmcnt(6)
    buffer_load_dwordx4 v[100:103], v19, s[8:11], s65 offen offset:0 nt
    s_waitcnt vmcnt(6)
    buffer_load_dwordx4 v[104:107], v18, s[8:11], s65 offen offset:2048 nt
    s_waitcnt vmcnt(6)
    buffer_load_dwordx4 v[108:111], v19, s[8:11], s65 offen offset:2048 nt
    s_add_u32 s65, s65, 16384
    s_branch L_kd2
L_km2_3:
    s_cmp_lg_u32 s63, 4
    s_cbranch_scc1 L_km2_4
    s_waitcnt vmcnt(8)
    buffer_load_dwordx4 v[96:99], v18, s[8:11], s65 offen offset:0 nt
    s_waitcnt vmcnt(8)
    buffer_load_dwordx4 v[100:103], v19, s[8:11], s65 offen offset:0 nt
    s_waitcnt vmcnt(8)
    buffer_load_dwordx4 v[104:107], v18, s[8:11], s65 offen offset:2048 nt
    s_waitcnt vmcnt(8)
    buffer_load_dwordx4 v[108:111], v19, s[8:11], s65 offen offset:2048 nt
    s_add_u32 s65, s65, 16384
    s_branch L_kd2
L_km2_4:
    s_waitcnt vmcnt(15)
    buffer_load_dwordx4 v[96:99], v18, s[8:11], s65 offen offset:0 nt
    s_waitcnt vmcnt(15)
    buffer_load_dwordx4 v[100:103], v19, s[8:11], s65 offen offset:0 nt
    s_waitcnt vmcnt(15)
    buffer_load_dwordx4 v[104:107], v18, s[8:11], s65 offen offset:2048 nt
    s_waitcnt vmcnt(15)
    buffer_load_dwordx4 v[108:111], v19, s[8:11], s65 offen offset:2048 nt
    s_add_u32 s65, s65, 16384
L_kd2:
    v_add_f32_dpp v24, v40, v41 row_ror:8 row_mask:0xf bank_mask:0xf
    v_add_f32_dpp v25, v42, v43 row_ror:8 row_mask:0xf bank_mask:0xf
    v_add_f32_dpp v26, v44, v45 row_ror:8 row_mask:0xf bank_mask:0xf
    v_add_f32_dpp v27, v46, v47 row_ror:8 row_mask:0xf bank_mask:0xf
    v_cvt_pk_bf16_f32 v14, v24, v25
    v_cvt_pk_bf16_f32 v15, v26, v27
    v_max3_f32 v10, v24, v25, v10
    v_lshlrev_b32 v28, 16, v14
    v_and_b32 v29, 0xffff0000, v14
    v_lshlrev_b32 v30, 16, v15
    v_and_b32 v31, 0xffff0000, v15
    v_max3_f32 v10, v26, v27, v10
    v_mul_f32 v28, s69, v28
    v_mul_f32 v29, s69, v29
    v_mul_f32 v30, s69, v30
    v_mul_f32 v31, s69, v31
    v_cvt_pk_bf16_f32 v14, v28, v29
    v_cvt_pk_bf16_f32 v15, v30, v31
    s_mov_b64 exec, s[72:73]
    ds_write_b64 v13, v[14:15] offset:0
    s_mov_b64 exec, -1
    v_add_u32 v13, 32, v13
    s_sub_u32 s66, s66, 1
    s_cmp_eq_u32 s66, 0
    s_cbranch_scc1 L_t3
L_k3:
    s_cmp_lg_u32 s66, 4
    s_cbranch_scc1 L_kk3
    s_mov_b32 s8, s12
    s_mov_b32 s9, s13
    s_mov_b32 s65, s70
    v_mov_b32 v18, v16
    v_add_u32 v19, 256, v16
L_kk3:
    s_waitcnt lgkmcnt(0)
    v_readfirstlane_b32 s63, v0
    s_add_u32 s62, s66, s71
    v_mov_b32 v28, s62
    ds_read_b32 v0, v1 offset:19540
    ds_write_b32 v2, v28 offset:19536
    s_waitcnt vmcnt(12)
    v_mfma_f32_16x16x32_bf16 v[40:43], v[112:115], v[32:35], 0
    v_mfma_f32_16x16x32_bf16 v[44:47], v[120:123], v[32:35], 0
    v_mfma_f32_16x16x32_bf16 v[40:43], v[116:119], v[36:39], v[40:43]
    v_mfma_f32_16x16x32_bf16 v[44:47], v[124:127], v[36:39], v[44:47]
    s_cmp_lg_u32 s63, 0
    s_cbranch_scc1 L_km3_0
    s_waitcnt vmcnt(4)
    buffer_load_dwordx4 v[112:115], v18, s[8:11], s65 offen offset:0 nt
    s_waitcnt vmcnt(4)
    buffer_load_dwordx4 v[116:119], v19, s[8:11], s65 offen offset:0 nt
    s_waitcnt vmcnt(4)
    buffer_load_dwordx4 v[120:123], v18, s[8:11], s65 offen offset:2048 nt
    s_waitcnt vmcnt(4)
    buffer_load_dwordx4 v[124:127], v19, s[8:11], s65 offen offset:2048 nt
    s_add_u32 s65, s65, 16384
    s_branch L_kd3
L_km3_0:
    s_cmp_lg_u32 s63, 1
    s_cbranch_scc1 L_km3_1
    s_waitcnt vmcnt(4)
    buffer_load_dwordx4 v[112:115], v18, s[8:11], s65 offen offset:0 nt
    s_waitcnt vmcnt(4)
    buffer_load_dwordx4 v[116:119], v19, s[8:11], s65 offen offset:0 nt
    s_waitcnt vmcnt(4)
    buffer_load_dwordx4 v[120:123], v18, s[8:11], s65 offen offset:2048 nt
    s_waitcnt vmcnt(4)
    buffer_load_dwordx4 v[124:127], v19, s[8:11], s65 offen offset:2048 nt
    s_add_u32 s65, s65, 16384
    s_branch L_kd3
L_km3_1:
    s_cmp_lg_u32 s63, 2
    s_cbranch_scc1 L_km3_2
    s_waitcnt vmcnt(5)
    buffer_load_dwordx4 v[112:115], v18, s[8:11], s65 offen offset:0 nt
    s_waitcnt vmcnt(5)
    buffer_load_dwordx4 v[116:119], v19, s[8:11], s65 offen offset:0 nt
    s_waitcnt vmcnt(5)
    buffer_load_dwordx4 v[120:123], v18, s[8:11], s65 offen offset:2048 nt
    s_waitcnt vmcnt(5)
    buffer_load_dwordx4 v[124:127], v19, s[8:11], s65 offen offset:2048 nt
    s_add_u32 s65, s65, 16384
    s_branch L_kd3
L_km3_2:
    s_cmp_lg_u32 s63, 3
    s_cbranch_scc1 L_km3_3
    s_waitcnt vmcnt(5)
    buffer_load_dwordx4 v[112:115], v18, s[8:11], s65 offen offset:0 nt
    s_waitcnt vmcnt(5)
    buffer_load_dwordx4 v[116:119], v19, s[8:11], s65 offen offset:0 nt
    s_waitcnt vmcnt(5)
    buffer_load_dwordx4 v[120:123], v18, s[8:11], s65 offen offset:2048 nt
    s_waitcnt vmcnt(5)
    buffer_load_dwordx4 v[124:127], v19, s[8:11], s65 offen offset:2048 nt
    s_add_u32 s65, s65, 16384
    s_branch L_kd3
L_km3_3:
    s_cmp_lg_u32 s63, 4
    s_cbranch_scc1 L_km3_4
    s_waitcnt vmcnt(8)
    buffer_load_dwordx4 v[112:115], v18, s[8:11], s65 offen offset:0 nt
    s_waitcnt vmcnt(8)
    buffer_load_dwordx4 v[116:119], v19, s[8:11], s65 offen offset:0 nt
    s_waitcnt vmcnt(8)
    buffer_load_dwordx4 v[120:123], v18, s[8:11], s65 offen offset:2048 nt
    s_waitcnt vmcnt(8)
    buffer_load_dwordx4 v[124:127], v19, s[8:11], s65 offen offset:2048 nt
    s_add_u32 s65, s65, 16384
    s_branch L_kd3
L_km3_4:
    s_waitcnt vmcnt(15)
    buffer_load_dwordx4 v[112:115], v18, s[8:11], s65 offen offset:0 nt
    s_waitcnt vmcnt(15)
    buffer_load_dwordx4 v[116:119], v19, s[8:11], s65 offen offset:0 nt
    s_waitcnt vmcnt(15)
    buffer_load_dwordx4 v[120:123], v18, s[8:11], s65 offen offset:2048 nt
    s_waitcnt vmcnt(15)
    buffer_load_dwordx4 v[124:127], v19, s[8:11], s65 offen offset:2048 nt
    s_add_u32 s65, s65, 16384
L_kd3:
    v_add_f32_dpp v24, v40, v41 row_ror:8 row_mask:0xf bank_mask:0xf
    v_add_f32_dpp v25, v42, v43 row_ror:8 row_mask:0xf bank_mask:0xf
    v_add_f32_dpp v26, v44, v45 row_ror:8 row_mask:0xf bank_mask:0xf
    v_add_f32_dpp v27, v46, v47 row_ror:8 row_mask:0xf bank_mask:0xf
    v_cvt_pk_bf16_f32 v14, v24, v25
    v_cvt_pk_bf16_f32 v15, v26, v27
    v_max3_f32 v10, v24, v25, v10
    v_lshlrev_b32 v28, 16, v14
    v_and_b32 v29, 0xffff0000, v14
    v_lshlrev_b32 v30, 16, v15
    v_and_b32 v31, 0xffff0000, v15
    v_max3_f32 v10, v26, v27, v10
    v_mul_f32 v28, s69, v28
    v_mul_f32 v29, s69, v29
    v_mul_f32 v30, s69, v30
    v_mul_f32 v31, s69, v31
    v_cvt_pk_bf16_f32 v14, v28, v29
    v_cvt_pk_bf16_f32 v15, v30, v31
    s_mov_b64 exec, s[72:73]
    ds_write_b64 v13, v[14:15] offset:0
    s_mov_b64 exec, -1
    v_add_u32 v13, 32, v13
    s_sub_u32 s66, s66, 1
    s_cmp_eq_u32 s66, 0
    s_cbranch_scc1 L_t0
    s_branch L_k0
L_t0:
    s_mov_b32 s61, 0
    s_branch L_tr
L_t1:
    s_mov_b32 s61, 1
    s_branch L_tr
L_t2:
    s_mov_b32 s61, 2
    s_branch L_tr
L_t3:
    s_mov_b32 s61, 3
L_tr:
    v_lshl_add_u32 v13, v3, 3, s64
    s_waitcnt lgkmcnt(0)
    ds_read_b64 v[14:15], v13
    v_max_f32_dpp v10, v10, v10 row_bcast:15 row_mask:0xa bank_mask:0xf
    s_nop 1
    v_max_f32_dpp v10, v10, v10 row_bcast:31 row_mask:0xc bank_mask:0xf
    s_nop 0
    v_readlane_b32 s67, v10, 63
    s_mov_b32 s66, s71
    s_nop 0
    v_mov_b32 v10, s67
    v_cvt_pk_bf16_f32 v10, v10, v10
    v_and_b32 v10, 0xffff0000, v10
    v_mul_f32 v10, s69, v10
    v_cvt_pk_bf16_f32 v10, v10, v10
    v_and_b32 v10, 0xffff0000, v10
    v_mul_f32 v12, s68, v10
    ds_write_b32 v9, v10
    s_cmp_eq_u32 s61, 1
    s_cbranch_scc1 L_v1
    s_cmp_eq_u32 s61, 2
    s_cbranch_scc1 L_v2
    s_cmp_eq_u32 s61, 3
    s_cbranch_scc1 L_v3
L_v0:
    s_cmp_le_u32 s66, 4
    s_cselect_b32 s10, 0, 2097152
    s_waitcnt lgkmcnt(0)
    v_lshlrev_b32 v28, 16, v14
    v_and_b32 v29, 0xffff0000, v14
    v_lshlrev_b32 v30, 16, v15
    v_and_b32 v31, 0xffff0000, v15
    v_add_u32 v13, 32, v13
    v_fma_f32 v28, v28, s68, -v12
    v_fma_f32 v29, v29, s68, -v12
    v_fma_f32 v30, v30, s68, -v12
    v_fma_f32 v31, v31, s68, -v12
    ds_read_b64 v[14:15], v13
    v_readfirstlane_b32 s63, v0
    v_mov_b32 v25, s66
    ds_read_b32 v0, v1 offset:19540
    ds_write_b32 v2, v25 offset:19536
    v_exp_f32 v28, v28
    v_exp_f32 v29, v29
    v_exp_f32 v30, v30
    v_exp_f32 v31, v31
    s_nop 0
    v_cvt_pk_bf16_f32 v28, v28, v28
    v_cvt_pk_bf16_f32 v29, v29, v29
    v_cvt_pk_bf16_f32 v30, v30, v30
    v_cvt_pk_bf16_f32 v31, v31, v31
    v_and_b32 v48, v28, v4
    v_and_b32 v49, v28, v5
    v_and_b32 v50, v28, v6
    v_and_b32 v51, v28, v7
    v_and_b32 v52, v29, v4
    v_and_b32 v53, v29, v5
    v_and_b32 v54, v29, v6
    v_and_b32 v55, v29, v7
    v_and_b32 v56, v30, v4
    v_and_b32 v57, v30, v5
    v_and_b32 v58, v30, v6
    v_and_b32 v59, v30, v7
    v_and_b32 v60, v31, v4
    v_and_b32 v61, v31, v5
    v_and_b32 v62, v31, v6
    v_and_b32 v63, v31, v7
    s_waitcnt vmcnt(12)
    s_nop 0
    v_mfma_f32_16x16x32_bf16 v[20:23], v[48:51], v[64:67], v[20:23]
    v_mfma_f32_16x16x32_bf16 v[20:23], v[52:55], v[68:71], v[20:23]
    v_mfma_f32_16x16x32_bf16 v[20:23], v[56:59], v[72:75], v[20:23]
    v_mfma_f32_16x16x32_bf16 v[20:23], v[60:63], v[76:79], v[20:23]
    s_sub_u32 s66, s66, 1
    s_cmp_eq_u32 s66, 0
    s_cbranch_scc1 L_sdone
    s_cmp_lt_u32 s66, 12
    s_cbranch_scc1 L_vf0
    s_cmp_lg_u32 s63, 0
    s_cbranch_scc1 L_vm0_0
    s_waitcnt vmcnt(4)
    buffer_load_dwordx4 v[64:67], v18, s[8:11], s65 offen offset:0 nt
    s_waitcnt vmcnt(4)
    buffer_load_dwordx4 v[68:71], v19, s[8:11], s65 offen offset:0 nt
    s_waitcnt vmcnt(4)
    buffer_load_dwordx4 v[72:75], v18, s[8:11], s65 offen offset:2048 nt
    s_waitcnt vmcnt(4)
    buffer_load_dwordx4 v[76:79], v19, s[8:11], s65 offen offset:2048 nt
    s_add_u32 s65, s65, 16384
    s_branch L_v1
L_vm0_0:
    s_cmp_lg_u32 s63, 1
    s_cbranch_scc1 L_vm0_1
    s_waitcnt vmcnt(5)
    buffer_load_dwordx4 v[64:67], v18, s[8:11], s65 offen offset:0 nt
    s_waitcnt vmcnt(5)
    buffer_load_dwordx4 v[68:71], v19, s[8:11], s65 offen offset:0 nt
    s_waitcnt vmcnt(5)
    buffer_load_dwordx4 v[72:75], v18, s[8:11], s65 offen offset:2048 nt
    s_waitcnt vmcnt(5)
    buffer_load_dwordx4 v[76:79], v19, s[8:11], s65 offen offset:2048 nt
    s_add_u32 s65, s65, 16384
    s_branch L_v1
L_vm0_1:
    s_cmp_lg_u32 s63, 2
    s_cbranch_scc1 L_vm0_2
    s_waitcnt vmcnt(5)
    buffer_load_dwordx4 v[64:67], v18, s[8:11], s65 offen offset:0 nt
    s_waitcnt vmcnt(5)
    buffer_load_dwordx4 v[68:71], v19, s[8:11], s65 offen offset:0 nt
    s_waitcnt vmcnt(5)
    buffer_load_dwordx4 v[72:75], v18, s[8:11], s65 offen offset:2048 nt
    s_waitcnt vmcnt(5)
    buffer_load_dwordx4 v[76:79], v19, s[8:11], s65 offen offset:2048 nt
    s_add_u32 s65, s65, 16384
    s_branch L_v1
L_vm0_2:
    s_cmp_lg_u32 s63, 3
    s_cbranch_scc1 L_vm0_3
    s_waitcnt vmcnt(6)
    buffer_load_dwordx4 v[64:67], v18, s[8:11], s65 offen offset:0 nt
    s_waitcnt vmcnt(6)
    buffer_load_dwordx4 v[68:71], v19, s[8:11], s65 offen offset:0 nt
    s_waitcnt vmcnt(6)
    buffer_load_dwordx4 v[72:75], v18, s[8:11], s65 offen offset:2048 nt
    s_waitcnt vmcnt(6)
    buffer_load_dwordx4 v[76:79], v19, s[8:11], s65 offen offset:2048 nt
    s_add_u32 s65, s65, 16384
    s_branch L_v1
L_vm0_3:
    s_cmp_lg_u32 s63, 4
    s_cbranch_scc1 L_vm0_4
    s_waitcnt vmcnt(8)
    buffer_load_dwordx4 v[64:67], v18, s[8:11], s65 offen offset:0 nt
    s_waitcnt vmcnt(8)
    buffer_load_dwordx4 v[68:71], v19, s[8:11], s65 offen offset:0 nt
    s_waitcnt vmcnt(8)
    buffer_load_dwordx4 v[72:75], v18, s[8:11], s65 offen offset:2048 nt
    s_waitcnt vmcnt(8)
    buffer_load_dwordx4 v[76:79], v19, s[8:11], s65 offen offset:2048 nt
    s_add_u32 s65, s65, 16384
    s_branch L_v1
L_vm0_4:
    s_waitcnt vmcnt(15)
    buffer_load_dwordx4 v[64:67], v18, s[8:11], s65 offen offset:0 nt
    s_waitcnt vmcnt(15)
    buffer_load_dwordx4 v[68:71], v19, s[8:11], s65 offen offset:0 nt
    s_waitcnt vmcnt(15)
    buffer_load_dwordx4 v[72:75], v18, s[8:11], s65 offen offset:2048 nt
    s_waitcnt vmcnt(15)
    buffer_load_dwordx4 v[76:79], v19, s[8:11], s65 offen offset:2048 nt
    s_add_u32 s65, s65, 16384
    s_branch L_v1
L_vf0:
    buffer_load_dwordx4 v[64:67], v18, s[8:11], s65 offen offset:0 nt
    buffer_load_dwordx4 v[68:71], v19, s[8:11], s65 offen offset:0 nt
    buffer_load_dwordx4 v[72:75], v18, s[8:11], s65 offen offset:2048 nt
    buffer_load_dwordx4 v[76:79], v19, s[8:11], s65 offen offset:2048 nt
    s_add_u32 s65, s65, 16384
L_v1:
    s_cmp_le_u32 s66, 4
    s_cselect_b32 s10, 0, 2097152
    s_waitcnt lgkmcnt(0)
    v_lshlrev_b32 v28, 16, v14
    v_and_b32 v29, 0xffff0000, v14
    v_lshlrev_b32 v30, 16, v15
    v_and_b32 v31, 0xffff0000, v15
    v_add_u32 v13, 32, v13
    v_fma_f32 v28, v28, s68, -v12
    v_fma_f32 v29, v29, s68, -v12
    v_fma_f32 v30, v30, s68, -v12
    v_fma_f32 v31, v31, s68, -v12
    ds_read_b64 v[14:15], v13
    v_readfirstlane_b32 s63, v0
    v_mov_b32 v25, s66
    ds_read_b32 v0, v1 offset:19540
    ds_write_b32 v2, v25 offset:19536
    v_exp_f32 v28, v28
    v_exp_f32 v29, v29
    v_exp_f32 v30, v30
    v_exp_f32 v31, v31
    s_nop 0
    v_cvt_pk_bf16_f32 v28, v28, v28
    v_cvt_pk_bf16_f32 v29, v29, v29
    v_cvt_pk_bf16_f32 v30, v30, v30
    v_cvt_pk_bf16_f32 v31, v31, v31
    v_and_b32 v48, v28, v4
    v_and_b32 v49, v28, v5
    v_and_b32 v50, v28, v6
    v_and_b32 v51, v28, v7
    v_and_b32 v52, v29, v4
    v_and_b32 v53, v29, v5
    v_and_b32 v54, v29, v6
    v_and_b32 v55, v29, v7
    v_and_b32 v56, v30, v4
    v_and_b32 v57, v30, v5
    v_and_b32 v58, v30, v6
    v_and_b32 v59, v30, v7
    v_and_b32 v60, v31, v4
    v_and_b32 v61, v31, v5
    v_and_b32 v62, v31, v6
    v_and_b32 v63, v31, v7
    s_waitcnt vmcnt(12)
    s_nop 0
    v_mfma_f32_16x16x32_bf16 v[20:23], v[48:51], v[80:83], v[20:23]
    v_mfma_f32_16x16x32_bf16 v[20:23], v[52:55], v[84:87], v[20:23]
    v_mfma_f32_16x16x32_bf16 v[20:23], v[56:59], v[88:91], v[20:23]
    v_mfma_f32_16x16x32_bf16 v[20:23], v[60:63], v[92:95], v[20:23]
    s_sub_u32 s66, s66, 1
    s_cmp_eq_u32 s66, 0
    s_cbranch_scc1 L_sdone
    s_cmp_lt_u32 s66, 12
    s_cbranch_scc1 L_vf1
    s_cmp_lg_u32 s63, 0
    s_cbranch_scc1 L_vm1_0
    s_waitcnt vmcnt(4)
    buffer_load_dwordx4 v[80:83], v18, s[8:11], s65 offen offset:0 nt
    s_waitcnt vmcnt(4)
    buffer_load_dwordx4 v[84:87], v19, s[8:11], s65 offen offset:0 nt
    s_waitcnt vmcnt(4)
    buffer_load_dwordx4 v[88:91], v18, s[8:11], s65 offen offset:2048 nt
    s_waitcnt vmcnt(4)
    buffer_load_dwordx4 v[92:95], v19, s[8:11], s65 offen offset:2048 nt
    s_add_u32 s65, s65, 16384
    s_branch L_v2
L_vm1_0:
    s_cmp_lg_u32 s63, 1
    s_cbranch_scc1 L_vm1_1
    s_waitcnt vmcnt(4)
    buffer_load_dwordx4 v[80:83], v18, s[8:11], s65 offen offset:0 nt
    s_waitcnt vmcnt(4)
    buffer_load_dwordx4 v[84:87], v19, s[8:11], s65 offen offset:0 nt
    s_waitcnt vmcnt(4)
    buffer_load_dwordx4 v[88:91], v18, s[8:11], s65 offen offset:2048 nt
    s_waitcnt vmcnt(4)
    buffer_load_dwordx4 v[92:95], v19, s[8:11], s65 offen offset:2048 nt
    s_add_u32 s65, s65, 16384
    s_branch L_v2
L_vm1_1:
    s_cmp_lg_u32 s63, 2
    s_cbranch_scc1 L_vm1_2
    s_waitcnt vmcnt(5)
    buffer_load_dwordx4 v[80:83], v18, s[8:11], s65 offen offset:0 nt
    s_waitcnt vmcnt(5)
    buffer_load_dwordx4 v[84:87], v19, s[8:11], s65 offen offset:0 nt
    s_waitcnt vmcnt(5)
    buffer_load_dwordx4 v[88:91], v18, s[8:11], s65 offen offset:2048 nt
    s_waitcnt vmcnt(5)
    buffer_load_dwordx4 v[92:95], v19, s[8:11], s65 offen offset:2048 nt
    s_add_u32 s65, s65, 16384
    s_branch L_v2
L_vm1_2:
    s_cmp_lg_u32 s63, 3
    s_cbranch_scc1 L_vm1_3
    s_waitcnt vmcnt(5)
    buffer_load_dwordx4 v[80:83], v18, s[8:11], s65 offen offset:0 nt
    s_waitcnt vmcnt(5)
    buffer_load_dwordx4 v[84:87], v19, s[8:11], s65 offen offset:0 nt
    s_waitcnt vmcnt(5)
    buffer_load_dwordx4 v[88:91], v18, s[8:11], s65 offen offset:2048 nt
    s_waitcnt vmcnt(5)
    buffer_load_dwordx4 v[92:95], v19, s[8:11], s65 offen offset:2048 nt
    s_add_u32 s65, s65, 16384
    s_branch L_v2
L_vm1_3:
    s_cmp_lg_u32 s63, 4
    s_cbranch_scc1 L_vm1_4
    s_waitcnt vmcnt(8)
    buffer_load_dwordx4 v[80:83], v18, s[8:11], s65 offen offset:0 nt
    s_waitcnt vmcnt(8)
    buffer_load_dwordx4 v[84:87], v19, s[8:11], s65 offen offset:0 nt
    s_waitcnt vmcnt(8)
    buffer_load_dwordx4 v[88:91], v18, s[8:11], s65 offen offset:2048 nt
    s_waitcnt vmcnt(8)
    buffer_load_dwordx4 v[92:95], v19, s[8:11], s65 offen offset:2048 nt
    s_add_u32 s65, s65, 16384
    s_branch L_v2
L_vm1_4:
    s_waitcnt vmcnt(15)
    buffer_load_dwordx4 v[80:83], v18, s[8:11], s65 offen offset:0 nt
    s_waitcnt vmcnt(15)
    buffer_load_dwordx4 v[84:87], v19, s[8:11], s65 offen offset:0 nt
    s_waitcnt vmcnt(15)
    buffer_load_dwordx4 v[88:91], v18, s[8:11], s65 offen offset:2048 nt
    s_waitcnt vmcnt(15)
    buffer_load_dwordx4 v[92:95], v19, s[8:11], s65 offen offset:2048 nt
    s_add_u32 s65, s65, 16384
    s_branch L_v2
L_vf1:
    buffer_load_dwordx4 v[80:83], v18, s[8:11], s65 offen offset:0 nt
    buffer_load_dwordx4 v[84:87], v19, s[8:11], s65 offen offset:0 nt
    buffer_load_dwordx4 v[88:91], v18, s[8:11], s65 offen offset:2048 nt
    buffer_load_dwordx4 v[92:95], v19, s[8:11], s65 offen offset:2048 nt
    s_add_u32 s65, s65, 16384
L_v2:
    s_cmp_le_u32 s66, 4
    s_cselect_b32 s10, 0, 2097152
    s_waitcnt lgkmcnt(0)
    v_lshlrev_b32 v28, 16, v14
    v_and_b32 v29, 0xffff0000, v14
    v_lshlrev_b32 v30, 16, v15
    v_and_b32 v31, 0xffff0000, v15
    v_add_u32 v13, 32, v13
    v_fma_f32 v28, v28, s68, -v12
    v_fma_f32 v29, v29, s68, -v12
    v_fma_f32 v30, v30, s68, -v12
    v_fma_f32 v31, v31, s68, -v12
    ds_read_b64 v[14:15], v13
    v_readfirstlane_b32 s63, v0
    v_mov_b32 v25, s66
    ds_read_b32 v0, v1 offset:19540
    ds_write_b32 v2, v25 offset:19536
    v_exp_f32 v28, v28
    v_exp_f32 v29, v29
    v_exp_f32 v30, v30
    v_exp_f32 v31, v31
    s_nop 0
    v_cvt_pk_bf16_f32 v28, v28, v28
    v_cvt_pk_bf16_f32 v29, v29, v29
    v_cvt_pk_bf16_f32 v30, v30, v30
    v_cvt_pk_bf16_f32 v31, v31, v31
    v_and_b32 v48, v28, v4
    v_and_b32 v49, v28, v5
    v_and_b32 v50, v28, v6
    v_and_b32 v51, v28, v7
    v_and_b32 v52, v29, v4
    v_and_b32 v53, v29, v5
    v_and_b32 v54, v29, v6
    v_and_b32 v55, v29, v7
    v_and_b32 v56, v30, v4
    v_and_b32 v57, v30, v5
    v_and_b32 v58, v30, v6
    v_and_b32 v59, v30, v7
    v_and_b32 v60, v31, v4
    v_and_b32 v61, v31, v5
    v_and_b32 v62, v31, v6
    v_and_b32 v63, v31, v7
    s_waitcnt vmcnt(12)
    s_nop 0
    v_mfma_f32_16x16x32_bf16 v[20:23], v[48:51], v[96:99], v[20:23]
    v_mfma_f32_16x16x32_bf16 v[20:23], v[52:55], v[100:103], v[20:23]
    v_mfma_f32_16x16x32_bf16 v[20:23], v[56:59], v[104:107], v[20:23]
    v_mfma_f32_16x16x32_bf16 v[20:23], v[60:63], v[108:111], v[20:23]
    s_sub_u32 s66, s66, 1
    s_cmp_eq_u32 s66, 0
    s_cbranch_scc1 L_sdone
    s_cmp_lt_u32 s66, 12
    s_cbranch_scc1 L_vf2
    s_cmp_lg_u32 s63, 0
    s_cbranch_scc1 L_vm2_0
    s_waitcnt vmcnt(4)
    buffer_load_dwordx4 v[96:99], v18, s[8:11], s65 offen offset:0 nt
    s_waitcnt vmcnt(4)
    buffer_load_dwordx4 v[100:103], v19, s[8:11], s65 offen offset:0 nt
    s_waitcnt vmcnt(4)
    buffer_load_dwordx4 v[104:107], v18, s[8:11], s65 offen offset:2048 nt
    s_waitcnt vmcnt(4)
    buffer_load_dwordx4 v[108:111], v19, s[8:11], s65 offen offset:2048 nt
    s_add_u32 s65, s65, 16384
    s_branch L_v3
L_vm2_0:
    s_cmp_lg_u32 s63, 1
    s_cbranch_scc1 L_vm2_1
    s_waitcnt vmcnt(5)
    buffer_load_dwordx4 v[96:99], v18, s[8:11], s65 offen offset:0 nt
    s_waitcnt vmcnt(5)
    buffer_load_dwordx4 v[100:103], v19, s[8:11], s65 offen offset:0 nt
    s_waitcnt vmcnt(5)
    buffer_load_dwordx4 v[104:107], v18, s[8:11], s65 offen offset:2048 nt
    s_waitcnt vmcnt(5)
    buffer_load_dwordx4 v[108:111], v19, s[8:11], s65 offen offset:2048 nt
    s_add_u32 s65, s65, 16384
    s_branch L_v3
L_vm2_1:
    s_cmp_lg_u32 s63, 2
    s_cbranch_scc1 L_vm2_2
    s_waitcnt vmcnt(5)
    buffer_load_dwordx4 v[96:99], v18, s[8:11], s65 offen offset:0 nt
    s_waitcnt vmcnt(5)
    buffer_load_dwordx4 v[100:103], v19, s[8:11], s65 offen offset:0 nt
    s_waitcnt vmcnt(5)
    buffer_load_dwordx4 v[104:107], v18, s[8:11], s65 offen offset:2048 nt
    s_waitcnt vmcnt(5)
    buffer_load_dwordx4 v[108:111], v19, s[8:11], s65 offen offset:2048 nt
    s_add_u32 s65, s65, 16384
    s_branch L_v3
L_vm2_2:
    s_cmp_lg_u32 s63, 3
    s_cbranch_scc1 L_vm2_3
    s_waitcnt vmcnt(6)
    buffer_load_dwordx4 v[96:99], v18, s[8:11], s65 offen offset:0 nt
    s_waitcnt vmcnt(6)
    buffer_load_dwordx4 v[100:103], v19, s[8:11], s65 offen offset:0 nt
    s_waitcnt vmcnt(6)
    buffer_load_dwordx4 v[104:107], v18, s[8:11], s65 offen offset:2048 nt
    s_waitcnt vmcnt(6)
    buffer_load_dwordx4 v[108:111], v19, s[8:11], s65 offen offset:2048 nt
    s_add_u32 s65, s65, 16384
    s_branch L_v3
L_vm2_3:
    s_cmp_lg_u32 s63, 4
    s_cbranch_scc1 L_vm2_4
    s_waitcnt vmcnt(8)
    buffer_load_dwordx4 v[96:99], v18, s[8:11], s65 offen offset:0 nt
    s_waitcnt vmcnt(8)
    buffer_load_dwordx4 v[100:103], v19, s[8:11], s65 offen offset:0 nt
    s_waitcnt vmcnt(8)
    buffer_load_dwordx4 v[104:107], v18, s[8:11], s65 offen offset:2048 nt
    s_waitcnt vmcnt(8)
    buffer_load_dwordx4 v[108:111], v19, s[8:11], s65 offen offset:2048 nt
    s_add_u32 s65, s65, 16384
    s_branch L_v3
L_vm2_4:
    s_waitcnt vmcnt(15)
    buffer_load_dwordx4 v[96:99], v18, s[8:11], s65 offen offset:0 nt
    s_waitcnt vmcnt(15)
    buffer_load_dwordx4 v[100:103], v19, s[8:11], s65 offen offset:0 nt
    s_waitcnt vmcnt(15)
    buffer_load_dwordx4 v[104:107], v18, s[8:11], s65 offen offset:2048 nt
    s_waitcnt vmcnt(15)
    buffer_load_dwordx4 v[108:111], v19, s[8:11], s65 offen offset:2048 nt
    s_add_u32 s65, s65, 16384
    s_branch L_v3
L_vf2:
    buffer_load_dwordx4 v[96:99], v18, s[8:11], s65 offen offset:0 nt
    buffer_load_dwordx4 v[100:103], v19, s[8:11], s65 offen offset:0 nt
    buffer_load_dwordx4 v[104:107], v18, s[8:11], s65 offen offset:2048 nt
    buffer_load_dwordx4 v[108:111], v19, s[8:11], s65 offen offset:2048 nt
    s_add_u32 s65, s65, 16384
L_v3:
    s_cmp_le_u32 s66, 4
    s_cselect_b32 s10, 0, 2097152
    s_waitcnt lgkmcnt(0)
    v_lshlrev_b32 v28, 16, v14
    v_and_b32 v29, 0xffff0000, v14
    v_lshlrev_b32 v30, 16, v15
    v_and_b32 v31, 0xffff0000, v15
    v_add_u32 v13, 32, v13
    v_fma_f32 v28, v28, s68, -v12
    v_fma_f32 v29, v29, s68, -v12
    v_fma_f32 v30, v30, s68, -v12
    v_fma_f32 v31, v31, s68, -v12
    ds_read_b64 v[14:15], v13
    v_readfirstlane_b32 s63, v0
    v_mov_b32 v25, s66
    ds_read_b32 v0, v1 offset:19540
    ds_write_b32 v2, v25 offset:19536
    v_exp_f32 v28, v28
    v_exp_f32 v29, v29
    v_exp_f32 v30, v30
    v_exp_f32 v31, v31
    s_nop 0
    v_cvt_pk_bf16_f32 v28, v28, v28
    v_cvt_pk_bf16_f32 v29, v29, v29
    v_cvt_pk_bf16_f32 v30, v30, v30
    v_cvt_pk_bf16_f32 v31, v31, v31
    v_and_b32 v48, v28, v4
    v_and_b32 v49, v28, v5
    v_and_b32 v50, v28, v6
    v_and_b32 v51, v28, v7
    v_and_b32 v52, v29, v4
    v_and_b32 v53, v29, v5
    v_and_b32 v54, v29, v6
    v_and_b32 v55, v29, v7
    v_and_b32 v56, v30, v4
    v_and_b32 v57, v30, v5
    v_and_b32 v58, v30, v6
    v_and_b32 v59, v30, v7
    v_and_b32 v60, v31, v4
    v_and_b32 v61, v31, v5
    v_and_b32 v62, v31, v6
    v_and_b32 v63, v31, v7
    s_waitcnt vmcnt(12)
    s_nop 0
    v_mfma_f32_16x16x32_bf16 v[20:23], v[48:51], v[112:115], v[20:23]
    v_mfma_f32_16x16x32_bf16 v[20:23], v[52:55], v[116:119], v[20:23]
    v_mfma_f32_16x16x32_bf16 v[20:23], v[56:59], v[120:123], v[20:23]
    v_mfma_f32_16x16x32_bf16 v[20:23], v[60:63], v[124:127], v[20:23]
    s_sub_u32 s66, s66, 1
    s_cmp_eq_u32 s66, 0
    s_cbranch_scc1 L_sdone
    s_cmp_lt_u32 s66, 12
    s_cbranch_scc1 L_vf3
    s_cmp_lg_u32 s63, 0
    s_cbranch_scc1 L_vm3_0
    s_waitcnt vmcnt(4)
    buffer_load_dwordx4 v[112:115], v18, s[8:11], s65 offen offset:0 nt
    s_waitcnt vmcnt(4)
    buffer_load_dwordx4 v[116:119], v19, s[8:11], s65 offen offset:0 nt
    s_waitcnt vmcnt(4)
    buffer_load_dwordx4 v[120:123], v18, s[8:11], s65 offen offset:2048 nt
    s_waitcnt vmcnt(4)
    buffer_load_dwordx4 v[124:127], v19, s[8:11], s65 offen offset:2048 nt
    s_add_u32 s65, s65, 16384
    s_branch L_v0
L_vm3_0:
    s_cmp_lg_u32 s63, 1
    s_cbranch_scc1 L_vm3_1
    s_waitcnt vmcnt(4)
    buffer_load_dwordx4 v[112:115], v18, s[8:11], s65 offen offset:0 nt
    s_waitcnt vmcnt(4)
    buffer_load_dwordx4 v[116:119], v19, s[8:11], s65 offen offset:0 nt
    s_waitcnt vmcnt(4)
    buffer_load_dwordx4 v[120:123], v18, s[8:11], s65 offen offset:2048 nt
    s_waitcnt vmcnt(4)
    buffer_load_dwordx4 v[124:127], v19, s[8:11], s65 offen offset:2048 nt
    s_add_u32 s65, s65, 16384
    s_branch L_v0
L_vm3_1:
    s_cmp_lg_u32 s63, 2
    s_cbranch_scc1 L_vm3_2
    s_waitcnt vmcnt(5)
    buffer_load_dwordx4 v[112:115], v18, s[8:11], s65 offen offset:0 nt
    s_waitcnt vmcnt(5)
    buffer_load_dwordx4 v[116:119], v19, s[8:11], s65 offen offset:0 nt
    s_waitcnt vmcnt(5)
    buffer_load_dwordx4 v[120:123], v18, s[8:11], s65 offen offset:2048 nt
    s_waitcnt vmcnt(5)
    buffer_load_dwordx4 v[124:127], v19, s[8:11], s65 offen offset:2048 nt
    s_add_u32 s65, s65, 16384
    s_branch L_v0
L_vm3_2:
    s_cmp_lg_u32 s63, 3
    s_cbranch_scc1 L_vm3_3
    s_waitcnt vmcnt(5)
    buffer_load_dwordx4 v[112:115], v18, s[8:11], s65 offen offset:0 nt
    s_waitcnt vmcnt(5)
    buffer_load_dwordx4 v[116:119], v19, s[8:11], s65 offen offset:0 nt
    s_waitcnt vmcnt(5)
    buffer_load_dwordx4 v[120:123], v18, s[8:11], s65 offen offset:2048 nt
    s_waitcnt vmcnt(5)
    buffer_load_dwordx4 v[124:127], v19, s[8:11], s65 offen offset:2048 nt
    s_add_u32 s65, s65, 16384
    s_branch L_v0
L_vm3_3:
    s_cmp_lg_u32 s63, 4
    s_cbranch_scc1 L_vm3_4
    s_waitcnt vmcnt(8)
    buffer_load_dwordx4 v[112:115], v18, s[8:11], s65 offen offset:0 nt
    s_waitcnt vmcnt(8)
    buffer_load_dwordx4 v[116:119], v19, s[8:11], s65 offen offset:0 nt
    s_waitcnt vmcnt(8)
    buffer_load_dwordx4 v[120:123], v18, s[8:11], s65 offen offset:2048 nt
    s_waitcnt vmcnt(8)
    buffer_load_dwordx4 v[124:127], v19, s[8:11], s65 offen offset:2048 nt
    s_add_u32 s65, s65, 16384
    s_branch L_v0
L_vm3_4:
    s_waitcnt vmcnt(15)
    buffer_load_dwordx4 v[112:115], v18, s[8:11], s65 offen offset:0 nt
    s_waitcnt vmcnt(15)
    buffer_load_dwordx4 v[116:119], v19, s[8:11], s65 offen offset:0 nt
    s_waitcnt vmcnt(15)
    buffer_load_dwordx4 v[120:123], v18, s[8:11], s65 offen offset:2048 nt
    s_waitcnt vmcnt(15)
    buffer_load_dwordx4 v[124:127], v19, s[8:11], s65 offen offset:2048 nt
    s_add_u32 s65, s65, 16384
    s_branch L_v0
L_vf3:
    buffer_load_dwordx4 v[112:115], v18, s[8:11], s65 offen offset:0 nt
    buffer_load_dwordx4 v[116:119], v19, s[8:11], s65 offen offset:0 nt
    buffer_load_dwordx4 v[120:123], v18, s[8:11], s65 offen offset:2048 nt
    buffer_load_dwordx4 v[124:127], v19, s[8:11], s65 offen offset:2048 nt
    s_add_u32 s65, s65, 16384
    s_branch L_v0
L_sdone:
    s_mov_b32 exec_lo, 0
    s_nop 3
    v_cvt_pk_bf16_f32 v20, v20, v21
    v_cvt_pk_bf16_f32 v21, v22, v23
    ds_write_b64 v8, v[20:21]
    s_mov_b64 exec, -1
    s_waitcnt lgkmcnt(0)
    s_barrier
    s_endpgm
L_aux2:
    v_and_b32 v9, 3, v9
    v_cmp_eq_u32 vcc, 0, v9
    s_nop 1
    v_cndmask_b32 v4, 0, v8, vcc
    v_cmp_eq_u32 vcc, 1, v9
    s_nop 1
    v_cndmask_b32 v5, 0, v8, vcc
    v_cmp_eq_u32 vcc, 2, v9
    s_nop 1
    v_cndmask_b32 v6, 0, v8, vcc
    v_cmp_eq_u32 vcc, 3, v9
    s_nop 1
    v_cndmask_b32 v7, 0, v8, vcc
    s_waitcnt vmcnt(10)
    v_lshlrev_b32 v20, 16, v14
    v_and_b32 v21, 0xffff0000, v14
    v_lshlrev_b32 v22, 16, v15
    v_and_b32 v23, 0xffff0000, v15
    v_lshlrev_b32 v24, 16, v16
    v_and_b32 v25, 0xffff0000, v16
    v_lshlrev_b32 v26, 16, v17
    v_and_b32 v27, 0xffff0000, v17
    v_lshlrev_b32 v28, 16, v18
    v_and_b32 v29, 0xffff0000, v18
    v_add_f32 v34, v20, v21
    v_add_f32 v34, v34, v22
    v_add_f32 v34, v34, v23
    v_add_f32 v34, v34, v24
    v_add_f32 v34, v34, v25
    v_add_f32 v34, v34, v26
    v_add_f32 v34, v34, v27
    v_add_f32 v34, v34, v28
    v_add_f32 v34, v34, v29
    s_nop 1
    v_add_f32_dpp v34, v34, v34 row_shr:1 row_mask:0xf bank_mask:0xf bound_ctrl:0
    s_nop 1
    v_add_f32_dpp v34, v34, v34 row_shr:2 row_mask:0xf bank_mask:0xf bound_ctrl:0
    s_nop 1
    v_add_f32_dpp v34, v34, v34 row_shr:4 row_mask:0xf bank_mask:0xf bound_ctrl:0
    s_nop 1
    v_add_f32_dpp v34, v34, v34 row_shr:8 row_mask:0xf bank_mask:0xf bound_ctrl:0
    s_nop 1
    v_add_f32_dpp v34, v34, v34 row_bcast:15 row_mask:0xa bank_mask:0xf
    s_nop 1
    v_add_f32_dpp v34, v34, v34 row_bcast:31 row_mask:0xc bank_mask:0xf
    s_nop 0
    v_readlane_b32 s61, v34, 63
    s_nop 1
    v_mov_b32 v35, 0x3acccccd
    v_mul_f32 v34, s61, v35
    v_sub_f32 v30, v20, v34
    v_mul_f32 v31, v30, v30
    v_sub_f32 v30, v21, v34
    v_fmac_f32 v31, v30, v30
    v_sub_f32 v30, v22, v34
    v_fmac_f32 v31, v30, v30
    v_sub_f32 v30, v23, v34
    v_fmac_f32 v31, v30, v30
    v_sub_f32 v30, v24, v34
    v_fmac_f32 v31, v30, v30
    v_sub_f32 v30, v25, v34
    v_fmac_f32 v31, v30, v30
    v_sub_f32 v30, v26, v34
    v_fmac_f32 v31, v30, v30
    v_sub_f32 v30, v27, v34
    v_fmac_f32 v31, v30, v30
    v_sub_f32 v30, v28, v34
    v_fmac_f32 v31, v30, v30
    v_sub_f32 v30, v29, v34
    v_fmac_f32 v31, v30, v30
    s_nop 1
    v_add_f32_dpp v31, v31, v31 row_shr:1 row_mask:0xf bank_mask:0xf bound_ctrl:0
    s_nop 1
    v_add_f32_dpp v31, v31, v31 row_shr:2 row_mask:0xf bank_mask:0xf bound_ctrl:0
    s_nop 1
    v_add_f32_dpp v31, v31, v31 row_shr:4 row_mask:0xf bank_mask:0xf bound_ctrl:0
    s_nop 1
    v_add_f32_dpp v31, v31, v31 row_shr:8 row_mask:0xf bank_mask:0xf bound_ctrl:0
    s_nop 1
    v_add_f32_dpp v31, v31, v31 row_bcast:15 row_mask:0xa bank_mask:0xf
    s_nop 1
    v_add_f32_dpp v31, v31, v31 row_bcast:31 row_mask:0xc bank_mask:0xf
    s_nop 0
    v_readlane_b32 s61, v31, 63
    s_nop 1
    v_mul_f32 v31, s61, v35
    v_cvt_pk_bf16_f32 v30, v34, v31
    v_lshlrev_b32 v34, 16, v30
    v_and_b32 v31, 0xffff0000, v30
    v_add_f32 v31, 0x3727c5ac, v31
    v_cvt_pk_bf16_f32 v31, v31, v31
    v_and_b32 v31, 0xffff0000, v31
    v_sqrt_f32 v31, v31
    s_nop 0
    v_cvt_pk_bf16_f32 v31, v31, v31
    v_and_b32 v31, 0xffff0000, v31
    v_rcp_f32 v31, v31
    v_sub_f32 v20, v20, v34
    v_sub_f32 v21, v21, v34
    v_sub_f32 v22, v22, v34
    v_sub_f32 v23, v23, v34
    v_sub_f32 v24, v24, v34
    v_sub_f32 v25, v25, v34
    v_sub_f32 v26, v26, v34
    v_sub_f32 v27, v27, v34
    v_sub_f32 v28, v28, v34
    v_sub_f32 v29, v29, v34
    s_mul_i32 s63, s70, 2560
    v_lshl_add_u32 v33, v1, 3, s63
    v_cvt_pk_bf16_f32 v14, v20, v21
    v_lshlrev_b32 v20, 16, v14
    v_and_b32 v21, 0xffff0000, v14
    v_mul_f32 v20, v20, v31
    v_mul_f32 v21, v21, v31
    v_cvt_pk_bf16_f32 v20, v20, v20
    v_cvt_pk_bf16_f32 v21, v21, v21
    ds_write_b64 v33, v[20:21] offset:0
    v_cvt_pk_bf16_f32 v15, v22, v23
    v_lshlrev_b32 v22, 16, v15
    v_and_b32 v23, 0xffff0000, v15
    v_mul_f32 v22, v22, v31
    v_mul_f32 v23, v23, v31
    v_cvt_pk_bf16_f32 v22, v22, v22
    v_cvt_pk_bf16_f32 v23, v23, v23
    ds_write_b64 v33, v[22:23] offset:512
    v_cvt_pk_bf16_f32 v16, v24, v25
    v_lshlrev_b32 v24, 16, v16
    v_and_b32 v25, 0xffff0000, v16
    v_mul_f32 v24, v24, v31
    v_mul_f32 v25, v25, v31
    v_cvt_pk_bf16_f32 v24, v24, v24
    v_cvt_pk_bf16_f32 v25, v25, v25
    ds_write_b64 v33, v[24:25] offset:1024
    v_cvt_pk_bf16_f32 v17, v26, v27
    v_lshlrev_b32 v26, 16, v17
    v_and_b32 v27, 0xffff0000, v17
    v_mul_f32 v26, v26, v31
    v_mul_f32 v27, v27, v31
    v_cvt_pk_bf16_f32 v26, v26, v26
    v_cvt_pk_bf16_f32 v27, v27, v27
    ds_write_b64 v33, v[26:27] offset:1536
    v_cvt_pk_bf16_f32 v18, v28, v29
    v_lshlrev_b32 v28, 16, v18
    v_and_b32 v29, 0xffff0000, v18
    v_mul_f32 v28, v28, v31
    v_mul_f32 v29, v29, v31
    v_cvt_pk_bf16_f32 v28, v28, v28
    v_cvt_pk_bf16_f32 v29, v29, v29
    ds_write_b64 v33, v[28:29] offset:2048
    s_mul_i32 s62, s70, 640
    s_add_u32 s61, s63, s62
    v_mul_u32_u24 v14, 160, v3
    v_add_u32 v14, s61, v14
    s_waitcnt lgkmcnt(0)
    s_lshl_b32 s62, s71, 4
    v_add_u32 v15, s62, v14
    s_add_u32 s62, s62, 16
    ds_read_b128 v[56:59], v15 offset:0
    s_cmp_eq_u32 s62, 160
    s_cselect_b32 s62, 0, s62
    v_add_u32 v16, s62, v14
    s_add_u32 s62, s62, 16
    ds_read_b128 v[60:63], v16 offset:0
    s_cmp_eq_u32 s62, 160
    s_cselect_b32 s62, 0, s62
    v_add_u32 v15, s62, v14
    s_add_u32 s62, s62, 16
    ds_read_b128 v[64:67], v15 offset:0
    s_cmp_eq_u32 s62, 160
    s_cselect_b32 s62, 0, s62
    v_add_u32 v16, s62, v14
    s_add_u32 s62, s62, 16
    ds_read_b128 v[68:71], v16 offset:0
    s_cmp_eq_u32 s62, 160
    s_cselect_b32 s62, 0, s62
    v_add_u32 v15, s62, v14
    s_add_u32 s62, s62, 16
    ds_read_b128 v[72:75], v15 offset:0
    s_cmp_eq_u32 s62, 160
    s_cselect_b32 s62, 0, s62
    v_add_u32 v16, s62, v14
    s_add_u32 s62, s62, 16
    ds_read_b128 v[76:79], v16 offset:0
    s_cmp_eq_u32 s62, 160
    s_cselect_b32 s62, 0, s62
    v_add_u32 v15, s62, v14
    s_add_u32 s62, s62, 16
    ds_read_b128 v[80:83], v15 offset:0
    s_cmp_eq_u32 s62, 160
    s_cselect_b32 s62, 0, s62
    v_add_u32 v16, s62, v14
    s_add_u32 s62, s62, 16
    ds_read_b128 v[84:87], v16 offset:0
    s_cmp_eq_u32 s62, 160
    s_cselect_b32 s62, 0, s62
    v_add_u32 v15, s62, v14
    s_add_u32 s62, s62, 16
    ds_read_b128 v[88:91], v15 offset:0
    s_cmp_eq_u32 s62, 160
    s_cselect_b32 s62, 0, s62
    v_add_u32 v16, s62, v14
    s_add_u32 s62, s62, 16
    ds_read_b128 v[92:95], v16 offset:0
    s_cmp_eq_u32 s62, 160
    s_cselect_b32 s62, 0, s62
    s_waitcnt lgkmcnt(0)
    s_barrier
    buffer_load_dwordx4 v[116:119], v11, s[8:11], s65 offen
    s_add_u32 s65, s65, 8192
    buffer_load_dwordx4 v[120:123], v11, s[8:11], s65 offen
    s_add_u32 s65, s65, 8192
    buffer_load_dwordx4 v[124:127], v11, s[8:11], s65 offen
    s_add_u32 s65, s65, 8192
    s_cmp_eq_u32 s65, 327680
    s_cselect_b32 s65, 0, s65
    buffer_load_dwordx4 v[128:131], v11, s[8:11], s65 offen
    s_add_u32 s65, s65, 8192
    buffer_load_dwordx4 v[132:135], v11, s[8:11], s65 offen
    s_add_u32 s65, s65, 8192
    buffer_load_dwordx4 v[136:139], v11, s[8:11], s65 offen
    s_add_u32 s65, s65, 8192
    buffer_load_dwordx4 v[140:143], v11, s[8:11], s65 offen
    s_add_u32 s65, s65, 8192
    s_cmp_eq_u32 s65, 327680
    s_cselect_b32 s65, 0, s65
    buffer_load_dwordx4 v[144:147], v11, s[8:11], s65 offen
    s_add_u32 s65, s65, 8192
    buffer_load_dwordx4 v[148:151], v11, s[8:11], s65 offen
    s_add_u32 s65, s65, 8192
    buffer_load_dwordx4 v[152:155], v11, s[8:11], s65 offen
    s_add_u32 s65, s65, 8192
    buffer_load_dwordx4 v[156:159], v11, s[8:11], s65 offen
    s_add_u32 s65, s65, 8192
    s_cmp_eq_u32 s65, 327680
    s_cselect_b32 s65, 0, s65
    buffer_load_dwordx4 v[160:163], v11, s[8:11], s65 offen
    s_add_u32 s65, s65, 8192
    buffer_load_dwordx4 v[164:167], v11, s[8:11], s65 offen
    s_add_u32 s65, s65, 8192
    buffer_load_dwordx4 v[168:171], v11, s[8:11], s65 offen
    s_add_u32 s65, s65, 8192
    buffer_load_dwordx4 v[172:175], v11, s[8:11], s65 offen
    s_add_u32 s65, s65, 8192
    s_cmp_eq_u32 s65, 327680
    s_cselect_b32 s65, 0, s65
    buffer_load_dwordx4 v[176:179], v11, s[8:11], s65 offen
    s_add_u32 s65, s65, 8192
    buffer_load_dwordx4 v[180:183], v11, s[8:11], s65 offen
    s_add_u32 s65, s65, 8192
    buffer_load_dwordx4 v[184:187], v11, s[8:11], s65 offen
    s_add_u32 s65, s65, 8192
    buffer_load_dwordx4 v[188:191], v11, s[8:11], s65 offen
    s_add_u32 s65, s65, 8192
    s_cmp_eq_u32 s65, 327680
    s_cselect_b32 s65, 0, s65
    buffer_load_dwordx4 v[192:195], v11, s[8:11], s65 offen
    s_add_u32 s65, s65, 8192
    buffer_load_dwordx4 v[196:199], v11, s[8:11], s65 offen
    s_add_u32 s65, s65, 8192
    buffer_load_dwordx4 v[200:203], v11, s[8:11], s65 offen
    s_add_u32 s65, s65, 8192
    buffer_load_dwordx4 v[204:207], v11, s[8:11], s65 offen
    s_add_u32 s65, s65, 8192
    s_cmp_eq_u32 s65, 327680
    s_cselect_b32 s65, 0, s65
    buffer_load_dwordx4 v[208:211], v11, s[8:11], s65 offen
    s_add_u32 s65, s65, 8192
    buffer_load_dwordx4 v[212:215], v11, s[8:11], s65 offen
    s_add_u32 s65, s65, 8192
    buffer_load_dwordx4 v[216:219], v11, s[8:11], s65 offen
    s_add_u32 s65, s65, 8192
    buffer_load_dwordx4 v[220:223], v11, s[8:11], s65 offen
    s_add_u32 s65, s65, 8192
    s_cmp_eq_u32 s65, 327680
    s_cselect_b32 s65, 0, s65
    buffer_load_dwordx4 v[224:227], v11, s[8:11], s65 offen
    s_add_u32 s65, s65, 8192
    buffer_load_dwordx4 v[228:231], v11, s[8:11], s65 offen
    s_add_u32 s65, s65, 8192
    buffer_load_dwordx4 v[232:235], v11, s[8:11], s65 offen
    s_add_u32 s65, s65, 8192
    buffer_load_dwordx4 v[236:239], v11, s[8:11], s65 offen
    s_add_u32 s65, s65, 8192
    s_cmp_eq_u32 s65, 327680
    s_cselect_b32 s65, 0, s65
    s_barrier
    buffer_load_dwordx4 v[240:243], v11, s[8:11], s65 offen
    s_add_u32 s65, s65, 8192
    buffer_load_dwordx4 v[244:247], v11, s[8:11], s65 offen
    s_add_u32 s65, s65, 8192
    buffer_load_dwordx4 v[248:251], v11, s[8:11], s65 offen
    s_add_u32 s65, s65, 8192
    buffer_load_dwordx4 v[252:255], v11, s[8:11], s65 offen
    s_add_u32 s65, s65, 8192
    s_cmp_eq_u32 s65, 327680
    s_cselect_b32 s65, 0, s65
    v_and_b32 v36, v56, v4
    v_and_b32 v37, v56, v5
    v_and_b32 v38, v56, v6
    v_and_b32 v39, v56, v7
    v_and_b32 v40, v57, v4
    v_and_b32 v41, v57, v5
    v_and_b32 v42, v57, v6
    v_and_b32 v43, v57, v7
    s_waitcnt vmcnt(36)
    v_mfma_f32_16x16x32_bf16 v[44:47], v[36:39], v[96:99], 0
    v_and_b32 v36, v58, v4
    v_and_b32 v37, v58, v5
    v_and_b32 v38, v58, v6
    v_and_b32 v39, v58, v7
    v_mfma_f32_16x16x32_bf16 v[44:47], v[40:43], v[100:103], v[44:47]
    v_and_b32 v40, v59, v4
    v_and_b32 v41, v59, v5
    v_and_b32 v42, v59, v6
    v_and_b32 v43, v59, v7
    v_mfma_f32_16x16x32_bf16 v[44:47], v[36:39], v[104:107], v[44:47]
    v_and_b32 v36, v60, v4
    v_and_b32 v37, v60, v5
    v_and_b32 v38, v60, v6
    v_and_b32 v39, v60, v7
    v_mfma_f32_16x16x32_bf16 v[44:47], v[40:43], v[108:111], v[44:47]
    v_and_b32 v40, v61, v4
    v_and_b32 v41, v61, v5
    v_and_b32 v42, v61, v6
    v_and_b32 v43, v61, v7
    s_waitcnt vmcnt(32)
    v_mfma_f32_16x16x32_bf16 v[44:47], v[36:39], v[112:115], v[44:47]
    v_and_b32 v36, v62, v4
    v_and_b32 v37, v62, v5
    v_and_b32 v38, v62, v6
    v_and_b32 v39, v62, v7
    v_mfma_f32_16x16x32_bf16 v[44:47], v[40:43], v[116:119], v[44:47]
    v_and_b32 v40, v63, v4
    v_and_b32 v41, v63, v5
    v_and_b32 v42, v63, v6
    v_and_b32 v43, v63, v7
    v_mfma_f32_16x16x32_bf16 v[44:47], v[36:39], v[120:123], v[44:47]
    v_and_b32 v36, v64, v4
    v_and_b32 v37, v64, v5
    v_and_b32 v38, v64, v6
    v_and_b32 v39, v64, v7
    v_mfma_f32_16x16x32_bf16 v[44:47], v[40:43], v[124:127], v[44:47]
    v_and_b32 v40, v65, v4
    v_and_b32 v41, v65, v5
    v_and_b32 v42, v65, v6
    v_and_b32 v43, v65, v7
    s_waitcnt vmcnt(28)
    v_mfma_f32_16x16x32_bf16 v[44:47], v[36:39], v[128:131], v[44:47]
    v_and_b32 v36, v66, v4
    v_and_b32 v37, v66, v5
    v_and_b32 v38, v66, v6
    v_and_b32 v39, v66, v7
    v_mfma_f32_16x16x32_bf16 v[44:47], v[40:43], v[132:135], v[44:47]
    v_and_b32 v40, v67, v4
    v_and_b32 v41, v67, v5
    v_and_b32 v42, v67, v6
    v_and_b32 v43, v67, v7
    v_mfma_f32_16x16x32_bf16 v[44:47], v[36:39], v[136:139], v[44:47]
    v_and_b32 v36, v68, v4
    v_and_b32 v37, v68, v5
    v_and_b32 v38, v68, v6
    v_and_b32 v39, v68, v7
    v_mfma_f32_16x16x32_bf16 v[44:47], v[40:43], v[140:143], v[44:47]
    v_and_b32 v40, v69, v4
    v_and_b32 v41, v69, v5
    v_and_b32 v42, v69, v6
    v_and_b32 v43, v69, v7
    s_waitcnt vmcnt(24)
    v_mfma_f32_16x16x32_bf16 v[44:47], v[36:39], v[144:147], v[44:47]
    v_and_b32 v36, v70, v4
    v_and_b32 v37, v70, v5
    v_and_b32 v38, v70, v6
    v_and_b32 v39, v70, v7
    v_mfma_f32_16x16x32_bf16 v[44:47], v[40:43], v[148:151], v[44:47]
    v_and_b32 v40, v71, v4
    v_and_b32 v41, v71, v5
    v_and_b32 v42, v71, v6
    v_and_b32 v43, v71, v7
    v_mfma_f32_16x16x32_bf16 v[44:47], v[36:39], v[152:155], v[44:47]
    v_and_b32 v36, v72, v4
    v_and_b32 v37, v72, v5
    v_and_b32 v38, v72, v6
    v_and_b32 v39, v72, v7
    v_mfma_f32_16x16x32_bf16 v[44:47], v[40:43], v[156:159], v[44:47]
    v_and_b32 v40, v73, v4
    v_and_b32 v41, v73, v5
    v_and_b32 v42, v73, v6
    v_and_b32 v43, v73, v7
    s_waitcnt vmcnt(20)
    v_mfma_f32_16x16x32_bf16 v[44:47], v[36:39], v[160:163], v[44:47]
    v_and_b32 v36, v74, v4
    v_and_b32 v37, v74, v5
    v_and_b32 v38, v74, v6
    v_and_b32 v39, v74, v7
    v_mfma_f32_16x16x32_bf16 v[44:47], v[40:43], v[164:167], v[44:47]
    v_and_b32 v40, v75, v4
    v_and_b32 v41, v75, v5
    v_and_b32 v42, v75, v6
    v_and_b32 v43, v75, v7
    v_mfma_f32_16x16x32_bf16 v[44:47], v[36:39], v[168:171], v[44:47]
    v_and_b32 v36, v76, v4
    v_and_b32 v37, v76, v5
    v_and_b32 v38, v76, v6
    v_and_b32 v39, v76, v7
    v_mfma_f32_16x16x32_bf16 v[44:47], v[40:43], v[172:175], v[44:47]
    v_and_b32 v40, v77, v4
    v_and_b32 v41, v77, v5
    v_and_b32 v42, v77, v6
    v_and_b32 v43, v77, v7
    s_waitcnt vmcnt(16)
    v_mfma_f32_16x16x32_bf16 v[44:47], v[36:39], v[176:179], v[44:47]
    v_and_b32 v36, v78, v4
    v_and_b32 v37, v78, v5
    v_and_b32 v38, v78, v6
    v_and_b32 v39, v78, v7
    v_mfma_f32_16x16x32_bf16 v[44:47], v[40:43], v[180:183], v[44:47]
    v_and_b32 v40, v79, v4
    v_and_b32 v41, v79, v5
    v_and_b32 v42, v79, v6
    v_and_b32 v43, v79, v7
    v_mfma_f32_16x16x32_bf16 v[44:47], v[36:39], v[184:187], v[44:47]
    v_and_b32 v36, v80, v4
    v_and_b32 v37, v80, v5
    v_and_b32 v38, v80, v6
    v_and_b32 v39, v80, v7
    v_mfma_f32_16x16x32_bf16 v[44:47], v[40:43], v[188:191], v[44:47]
    v_and_b32 v40, v81, v4
    v_and_b32 v41, v81, v5
    v_and_b32 v42, v81, v6
    v_and_b32 v43, v81, v7
    s_waitcnt vmcnt(12)
    v_mfma_f32_16x16x32_bf16 v[44:47], v[36:39], v[192:195], v[44:47]
    v_and_b32 v36, v82, v4
    v_and_b32 v37, v82, v5
    v_and_b32 v38, v82, v6
    v_and_b32 v39, v82, v7
    v_mfma_f32_16x16x32_bf16 v[44:47], v[40:43], v[196:199], v[44:47]
    v_and_b32 v40, v83, v4
    v_and_b32 v41, v83, v5
    v_and_b32 v42, v83, v6
    v_and_b32 v43, v83, v7
    v_mfma_f32_16x16x32_bf16 v[44:47], v[36:39], v[200:203], v[44:47]
    v_and_b32 v36, v84, v4
    v_and_b32 v37, v84, v5
    v_and_b32 v38, v84, v6
    v_and_b32 v39, v84, v7
    v_mfma_f32_16x16x32_bf16 v[44:47], v[40:43], v[204:207], v[44:47]
    v_and_b32 v40, v85, v4
    v_and_b32 v41, v85, v5
    v_and_b32 v42, v85, v6
    v_and_b32 v43, v85, v7
    s_waitcnt vmcnt(11)
    v_mfma_f32_16x16x32_bf16 v[44:47], v[36:39], v[208:211], v[44:47]
    v_and_b32 v36, v86, v4
    v_and_b32 v37, v86, v5
    v_and_b32 v38, v86, v6
    v_and_b32 v39, v86, v7
    s_waitcnt vmcnt(10)
    v_mfma_f32_16x16x32_bf16 v[44:47], v[40:43], v[212:215], v[44:47]
    v_and_b32 v40, v87, v4
    v_and_b32 v41, v87, v5
    v_and_b32 v42, v87, v6
    v_and_b32 v43, v87, v7
    s_waitcnt vmcnt(9)
    v_mfma_f32_16x16x32_bf16 v[44:47], v[36:39], v[216:219], v[44:47]
    v_and_b32 v36, v88, v4
    v_and_b32 v37, v88, v5
    v_and_b32 v38, v88, v6
    v_and_b32 v39, v88, v7
    s_waitcnt vmcnt(8)
    v_mfma_f32_16x16x32_bf16 v[44:47], v[40:43], v[220:223], v[44:47]
    v_and_b32 v40, v89, v4
    v_and_b32 v41, v89, v5
    v_and_b32 v42, v89, v6
    v_and_b32 v43, v89, v7
    s_waitcnt vmcnt(7)
    v_mfma_f32_16x16x32_bf16 v[44:47], v[36:39], v[224:227], v[44:47]
    v_and_b32 v36, v90, v4
    v_and_b32 v37, v90, v5
    v_and_b32 v38, v90, v6
    v_and_b32 v39, v90, v7
    s_waitcnt vmcnt(6)
    v_mfma_f32_16x16x32_bf16 v[44:47], v[40:43], v[228:231], v[44:47]
    v_and_b32 v40, v91, v4
    v_and_b32 v41, v91, v5
    v_and_b32 v42, v91, v6
    v_and_b32 v43, v91, v7
    s_waitcnt vmcnt(5)
    v_mfma_f32_16x16x32_bf16 v[44:47], v[36:39], v[232:235], v[44:47]
    v_and_b32 v36, v92, v4
    v_and_b32 v37, v92, v5
    v_and_b32 v38, v92, v6
    v_and_b32 v39, v92, v7
    s_waitcnt vmcnt(4)
    v_mfma_f32_16x16x32_bf16 v[44:47], v[40:43], v[236:239], v[44:47]
    v_and_b32 v40, v93, v4
    v_and_b32 v41, v93, v5
    v_and_b32 v42, v93, v6
    v_and_b32 v43, v93, v7
    s_waitcnt vmcnt(3)
    v_mfma_f32_16x16x32_bf16 v[44:47], v[36:39], v[240:243], v[44:47]
    v_and_b32 v36, v94, v4
    v_and_b32 v37, v94, v5
    v_and_b32 v38, v94, v6
    v_and_b32 v39, v94, v7
    s_waitcnt vmcnt(2)
    v_mfma_f32_16x16x32_bf16 v[44:47], v[40:43], v[244:247], v[44:47]
    v_and_b32 v40, v95, v4
    v_and_b32 v41, v95, v5
    v_and_b32 v42, v95, v6
    v_and_b32 v43, v95, v7
    s_waitcnt vmcnt(1)
    v_mfma_f32_16x16x32_bf16 v[44:47], v[36:39], v[248:251], v[44:47]
    s_nop 1
    s_waitcnt vmcnt(0)
    v_mfma_f32_16x16x32_bf16 v[44:47], v[40:43], v[252:255], v[44:47]
    s_lshl_b32 s61, s70, 9
    s_add_u32 s61, s61, 15360
    v_lshlrev_b32 v30, 5, v2
    v_lshl_add_u32 v30, v3, 4, v30
    v_add_u32 v30, s61, v30
    s_nop 3
    s_mov_b64 exec, 0xffffffff
    ds_write_b128 v30, v[44:47]
    s_mov_b64 exec, -1
    s_lshl_b32 s61, s70, 2
    v_mov_b32 v31, s61
    v_mov_b32 v32, 0
    ds_write_b32 v31, v32 offset:19520
    v_mov_b32 v33, -1
    ds_write_b32 v31, v33 offset:19456
    ds_write_b32 v32, v32 offset:19548
    v_mov_b32 v34, 1000
    v_mov_b32 v35, 1
    ds_write_b64 v32, v[34:35] offset:19536
    s_waitcnt lgkmcnt(0)
    s_barrier
    v_lshlrev_b32 v20, 16, v48
    v_and_b32 v21, 0xffff0000, v48
    v_lshlrev_b32 v22, 16, v49
    v_and_b32 v23, 0xffff0000, v49
    v_lshlrev_b32 v24, 16, v50
    v_and_b32 v25, 0xffff0000, v50
    v_lshlrev_b32 v26, 16, v51
    v_and_b32 v27, 0xffff0000, v51
    v_lshlrev_b32 v28, 16, v52
    v_and_b32 v29, 0xffff0000, v52
    v_add_f32 v34, v20, v21
    v_add_f32 v34, v34, v22
    v_add_f32 v34, v34, v23
    v_add_f32 v34, v34, v24
    v_add_f32 v34, v34, v25
    v_add_f32 v34, v34, v26
    v_add_f32 v34, v34, v27
    v_add_f32 v34, v34, v28
    v_add_f32 v34, v34, v29
    s_nop 1
    v_add_f32_dpp v34, v34, v34 row_shr:1 row_mask:0xf bank_mask:0xf bound_ctrl:0
    s_nop 1
    v_add_f32_dpp v34, v34, v34 row_shr:2 row_mask:0xf bank_mask:0xf bound_ctrl:0
    s_nop 1
    v_add_f32_dpp v34, v34, v34 row_shr:4 row_mask:0xf bank_mask:0xf bound_ctrl:0
    s_nop 1
    v_add_f32_dpp v34, v34, v34 row_shr:8 row_mask:0xf bank_mask:0xf bound_ctrl:0
    s_nop 1
    v_add_f32_dpp v34, v34, v34 row_bcast:15 row_mask:0xa bank_mask:0xf
    s_nop 1
    v_add_f32_dpp v34, v34, v34 row_bcast:31 row_mask:0xc bank_mask:0xf
    s_nop 0
    v_readlane_b32 s61, v34, 63
    s_nop 1
    v_mov_b32 v35, 0x3acccccd
    v_mul_f32 v34, s61, v35
    v_sub_f32 v30, v20, v34
    v_mul_f32 v31, v30, v30
    v_sub_f32 v30, v21, v34
    v_fmac_f32 v31, v30, v30
    v_sub_f32 v30, v22, v34
    v_fmac_f32 v31, v30, v30
    v_sub_f32 v30, v23, v34
    v_fmac_f32 v31, v30, v30
    v_sub_f32 v30, v24, v34
    v_fmac_f32 v31, v30, v30
    v_sub_f32 v30, v25, v34
    v_fmac_f32 v31, v30, v30
    v_sub_f32 v30, v26, v34
    v_fmac_f32 v31, v30, v30
    v_sub_f32 v30, v27, v34
    v_fmac_f32 v31, v30, v30
    v_sub_f32 v30, v28, v34
    v_fmac_f32 v31, v30, v30
    v_sub_f32 v30, v29, v34
    v_fmac_f32 v31, v30, v30
    s_nop 1
    v_add_f32_dpp v31, v31, v31 row_shr:1 row_mask:0xf bank_mask:0xf bound_ctrl:0
    s_nop 1
    v_add_f32_dpp v31, v31, v31 row_shr:2 row_mask:0xf bank_mask:0xf bound_ctrl:0
    s_nop 1
    v_add_f32_dpp v31, v31, v31 row_shr:4 row_mask:0xf bank_mask:0xf bound_ctrl:0
    s_nop 1
    v_add_f32_dpp v31, v31, v31 row_shr:8 row_mask:0xf bank_mask:0xf bound_ctrl:0
    s_nop 1
    v_add_f32_dpp v31, v31, v31 row_bcast:15 row_mask:0xa bank_mask:0xf
    s_nop 1
    v_add_f32_dpp v31, v31, v31 row_bcast:31 row_mask:0xc bank_mask:0xf
    s_nop 0
    v_readlane_b32 s61, v31, 63
    s_nop 1
    v_mul_f32 v31, s61, v35
    v_cvt_pk_bf16_f32 v30, v34, v31
    v_lshlrev_b32 v34, 16, v30
    v_and_b32 v31, 0xffff0000, v30
    v_add_f32 v31, 0x3727c5ac, v31
    v_cvt_pk_bf16_f32 v31, v31, v31
    v_and_b32 v31, 0xffff0000, v31
    v_sqrt_f32 v31, v31
    s_nop 0
    v_cvt_pk_bf16_f32 v31, v31, v31
    v_and_b32 v31, 0xffff0000, v31
    v_rcp_f32 v31, v31
    v_sub_f32 v20, v20, v34
    v_sub_f32 v21, v21, v34
    v_sub_f32 v22, v22, v34
    v_sub_f32 v23, v23, v34
    v_sub_f32 v24, v24, v34
    v_sub_f32 v25, v25, v34
    v_sub_f32 v26, v26, v34
    v_sub_f32 v27, v27, v34
    v_sub_f32 v28, v28, v34
    v_sub_f32 v29, v29, v34
    s_mul_i32 s62, s70, 1280
    v_add_u32 v32, s62, v10
    v_cvt_pk_bf16_f32 v48, v20, v21
    v_lshlrev_b32 v20, 16, v48
    v_and_b32 v21, 0xffff0000, v48
    v_mul_f32 v20, v20, v31
    v_mul_f32 v21, v21, v31
    v_cvt_pk_bf16_f32 v48, v20, v21
    ds_write_b32 v32, v48 offset:10240
    v_cvt_pk_bf16_f32 v49, v22, v23
    v_lshlrev_b32 v22, 16, v49
    v_and_b32 v23, 0xffff0000, v49
    v_mul_f32 v22, v22, v31
    v_mul_f32 v23, v23, v31
    v_cvt_pk_bf16_f32 v49, v22, v23
    ds_write_b32 v32, v49 offset:10496
    v_cvt_pk_bf16_f32 v50, v24, v25
    v_lshlrev_b32 v24, 16, v50
    v_and_b32 v25, 0xffff0000, v50
    v_mul_f32 v24, v24, v31
    v_mul_f32 v25, v25, v31
    v_cvt_pk_bf16_f32 v50, v24, v25
    ds_write_b32 v32, v50 offset:10752
    v_cvt_pk_bf16_f32 v51, v26, v27
    v_lshlrev_b32 v26, 16, v51
    v_and_b32 v27, 0xffff0000, v51
    v_mul_f32 v26, v26, v31
    v_mul_f32 v27, v27, v31
    v_cvt_pk_bf16_f32 v51, v26, v27
    ds_write_b32 v32, v51 offset:11008
    v_cvt_pk_bf16_f32 v52, v28, v29
    v_lshlrev_b32 v28, 16, v52
    v_and_b32 v29, 0xffff0000, v52
    v_mul_f32 v28, v28, v31
    v_mul_f32 v29, v29, v31
    v_cvt_pk_bf16_f32 v52, v28, v29
    ds_write_b32 v32, v52 offset:11264
    s_mov_b32 s16, s58
    s_mov_b32 s17, s59
    s_mov_b32 s18, 1114112
    s_mov_b32 s19, 0x20000
    s_mul_i32 s74, s74, 0x9e3779b1
    s_add_u32 s74, s74, 0x7f4a7c15
    s_lshl_b32 s71, s60, 1
    s_add_u32 s71, s71, s6
    s_lshl_b32 s61, s7, 6
    s_add_u32 s61, s61, s71
    s_lshl_b32 s62, s61, 6
    v_lshrrev_b32 v13, 2, v0
    v_lshlrev_b32 v13, 14, v13
    v_and_b32 v30, 3, v0
    v_lshl_add_u32 v13, v30, 4, v13
    v_add_u32 v13, s62, v13
    s_lshr_b32 s62, s61, 1
    s_lshl_b32 s62, s62, 7
    s_lshl_b32 s63, s6, 3
    s_add_u32 s62, s62, s63
    s_add_u32 s62, s62, 655360
    v_mov_b32 v12, s62
    v_mov_b32 v30, -1
    v_mov_b32 v31, -1
    v_mov_b32 v32, -1
    v_mov_b32 v33, -1
    v_cmp_gt_u32 vcc, 160, v0
    s_and_saveexec_b64 s[72:73], vcc
    s_cbranch_execz L_noclr
    buffer_store_dwordx4 v[30:33], v13, s[16:19], 0 offen sc1
L_noclr:
    s_mov_b64 exec, s[72:73]
    v_cmp_eq_u32 vcc, 192, v0
    s_and_saveexec_b64 s[72:73], vcc
    s_cbranch_execz L_noclr2
    buffer_store_dwordx2 v[30:31], v12, s[16:19], 0 offen sc1
L_noclr2:
    s_mov_b64 exec, s[72:73]
    s_waitcnt vmcnt(0) lgkmcnt(0)
    s_lshl_b32 s61, s70, 2
    v_mov_b32 v30, s61
    v_mov_b32 v31, 1
    ds_write_b32 v30, v31 offset:19520
    s_bfm_b32 s61, s4, 0
    s_and_b32 s61, s61, 0x15
    s_bcnt1_i32_b32 s61, s61
    s_lshr_b32 s62, s5, 1
    s_mul_i32 s63, s4, 12
    s_lshl_b32 s64, s61, 2
    s_add_u32 s63, s63, s64
    s_add_u32 s63, s63, s62
    s_cmp_eq_u32 s6, 1
    s_cselect_b32 s63, s63, 255
    s_sub_u32 s64, s4, s61
    s_lshl_b32 s64, s64, 3
    s_add_u32 s64, s64, s5
    s_add_u32 s64, s64, 104
    s_cmp_lt_u32 s62, s95
    s_cselect_b32 s75, s63, s64
    s_cmp_lg_u32 s70, 0
    s_cbranch_scc1 L_wo
    v_mov_b32 v34, 0
L_flg:
    ds_read_b128 v[20:23], v34 offset:19520
    s_waitcnt lgkmcnt(0)
    v_add3_u32 v20, v20, v21, v22
    v_add_u32 v20, v20, v23
    v_cmp_ne_u32 vcc, 4, v20
    s_nop 1
    s_cbranch_vccnz L_flg
    s_lshl_b32 s64, s2, 7
    s_add_u32 s64, s64, 671744
    v_mov_b32 v34, s64
    v_mov_b32 v35, s74
    s_mov_b64 exec, 1
    buffer_store_dword v35, v34, s[16:19], 0 offen sc1
    s_mov_b64 exec, -1
L_wo:
    s_mul_i32 s61, s60, 163840
    s_add_u32 s12, s44, s61
    s_addc_u32 s13, s45, 0
    s_mov_b32 s14, 163840
    s_mov_b32 s15, 0x20000
    s_mul_i32 s62, s70, 320
    s_mov_b32 s63, 52429
    v_add_u32 v36, 0, v1
    v_mul_u32_u24 v41, s63, v36
    v_lshrrev_b32 v41, 20, v41
    v_mul_u32_u24 v42, 960, v41
    v_lshl_add_u32 v36, v36, 4, v42
    v_add_u32 v36, s62, v36
    v_add_u32 v37, 64, v1
    v_mul_u32_u24 v41, s63, v37
    v_lshrrev_b32 v41, 20, v41
    v_mul_u32_u24 v42, 960, v41
    v_lshl_add_u32 v37, v37, 4, v42
    v_add_u32 v37, s62, v37
    v_add_u32 v38, 128, v1
    v_mul_u32_u24 v41, s63, v38
    v_lshrrev_b32 v41, 20, v41
    v_mul_u32_u24 v42, 960, v41
    v_lshl_add_u32 v38, v38, 4, v42
    v_add_u32 v38, s62, v38
    v_add_u32 v39, 192, v1
    v_mul_u32_u24 v41, s63, v39
    v_lshrrev_b32 v41, 20, v41
    v_mul_u32_u24 v42, 960, v41
    v_lshl_add_u32 v39, v39, 4, v42
    v_add_u32 v39, s62, v39
    v_add_u32 v40, 256, v1
    v_mul_u32_u24 v41, s63, v40
    v_lshrrev_b32 v41, 20, v41
    v_mul_u32_u24 v42, 960, v41
    v_lshl_add_u32 v40, v40, 4, v42
    v_add_u32 v40, s62, v40
    s_mul_i32 s62, s70, 10240
    s_add_u32 s62, s62, 32608
    v_lshrrev_b32 v41, 2, v2
    v_lshl_add_u32 v41, v3, 3, v41
    v_mul_u32_u24 v41, 320, v41
    v_and_b32 v42, 3, v1
    v_lshl_add_u32 v41, v42, 3, v41
    v_add_u32 v41, s62, v41
    s_mov_b32 s65, 0
    s_add_u32 m0, s62, 0
    s_nop 0
    buffer_load_dwordx4 v36, s[12:15], s65 offen  lds
    s_waitcnt vmcnt(1)
    s_add_u32 m0, s62, 1024
    s_nop 0
    buffer_load_dwordx4 v37, s[12:15], s65 offen  lds
    s_waitcnt vmcnt(1)
    s_add_u32 m0, s62, 2048
    s_nop 0
    buffer_load_dwordx4 v38, s[12:15], s65 offen  lds
    s_waitcnt vmcnt(1)
    s_add_u32 m0, s62, 3072
    s_nop 0
    buffer_load_dwordx4 v39, s[12:15], s65 offen  lds
    s_waitcnt vmcnt(1)
    s_add_u32 m0, s62, 4096
    s_nop 0
    buffer_load_dwordx4 v40, s[12:15], s65 offen  lds
    s_waitcnt vmcnt(1)
    s_add_u32 m0, s62, 5120
    s_add_u32 s65, s65, 20480
    buffer_load_dwordx4 v36, s[12:15], s65 offen  lds
    s_waitcnt vmcnt(1)
    s_add_u32 m0, s62, 6144
    s_nop 0
    buffer_load_dwordx4 v37, s[12:15], s65 offen  lds
    s_waitcnt vmcnt(1)
    s_add_u32 m0, s62, 7168
    s_nop 0
    buffer_load_dwordx4 v38, s[12:15], s65 offen  lds
    s_waitcnt vmcnt(1)
    s_add_u32 m0, s62, 8192
    s_nop 0
    buffer_load_dwordx4 v39, s[12:15], s65 offen  lds
    s_waitcnt vmcnt(1)
    s_add_u32 m0, s62, 9216
    s_nop 0
    buffer_load_dwordx4 v40, s[12:15], s65 offen  lds
    s_waitcnt vmcnt(1)
    s_add_u32 s65, s65, 20480
    s_waitcnt vmcnt(0)
    ds_read_b64_tr_b16 v[96:97], v41 offset:0
    ds_read_b64_tr_b16 v[98:99], v41 offset:1280
    ds_read_b64_tr_b16 v[112:113], v41 offset:32
    ds_read_b64_tr_b16 v[114:115], v41 offset:1312
    ds_read_b64_tr_b16 v[128:129], v41 offset:64
    ds_read_b64_tr_b16 v[130:131], v41 offset:1344
    ds_read_b64_tr_b16 v[144:145], v41 offset:96
    ds_read_b64_tr_b16 v[146:147], v41 offset:1376
    ds_read_b64_tr_b16 v[160:161], v41 offset:128
    ds_read_b64_tr_b16 v[162:163], v41 offset:1408
    ds_read_b64_tr_b16 v[176:177], v41 offset:160
    ds_read_b64_tr_b16 v[178:179], v41 offset:1440
    s_waitcnt lgkmcnt(4)
    ds_read_b64_tr_b16 v[192:193], v41 offset:192
    ds_read_b64_tr_b16 v[194:195], v41 offset:1472
    ds_read_b64_tr_b16 v[208:209], v41 offset:224
    ds_read_b64_tr_b16 v[210:211], v41 offset:1504
    ds_read_b64_tr_b16 v[224:225], v41 offset:256
    ds_read_b64_tr_b16 v[226:227], v41 offset:1536
    ds_read_b64_tr_b16 v[240:241], v41 offset:288
    ds_read_b64_tr_b16 v[242:243], v41 offset:1568
    s_waitcnt lgkmcnt(0)
    s_add_u32 m0, s62, 0
    s_nop 0
    buffer_load_dwordx4 v36, s[12:15], s65 offen  lds
    s_waitcnt vmcnt(1)
    s_add_u32 m0, s62, 1024
    s_nop 0
    buffer_load_dwordx4 v37, s[12:15], s65 offen  lds
    s_waitcnt vmcnt(1)
    s_add_u32 m0, s62, 2048
    s_nop 0
    buffer_load_dwordx4 v38, s[12:15], s65 offen  lds
    s_waitcnt vmcnt(1)
    s_add_u32 m0, s62, 3072
    s_nop 0
    buffer_load_dwordx4 v39, s[12:15], s65 offen  lds
    s_waitcnt vmcnt(1)
    s_add_u32 m0, s62, 4096
    s_nop 0
    buffer_load_dwordx4 v40, s[12:15], s65 offen  lds
    s_waitcnt vmcnt(1)
    s_add_u32 m0, s62, 5120
    s_add_u32 s65, s65, 20480
    buffer_load_dwordx4 v36, s[12:15], s65 offen  lds
    s_waitcnt vmcnt(1)
    s_add_u32 m0, s62, 6144
    s_nop 0
    buffer_load_dwordx4 v37, s[12:15], s65 offen  lds
    s_waitcnt vmcnt(1)
    s_add_u32 m0, s62, 7168
    s_nop 0
    buffer_load_dwordx4 v38, s[12:15], s65 offen  lds
    s_waitcnt vmcnt(1)
    s_add_u32 m0, s62, 8192
    s_nop 0
    buffer_load_dwordx4 v39, s[12:15], s65 offen  lds
    s_waitcnt vmcnt(1)
    s_add_u32 m0, s62, 9216
    s_nop 0
    buffer_load_dwordx4 v40, s[12:15], s65 offen  lds
    s_waitcnt vmcnt(1)
    s_add_u32 s65, s65, 20480
    s_waitcnt vmcnt(0)
    ds_read_b64_tr_b16 v[100:101], v41 offset:0
    ds_read_b64_tr_b16 v[102:103], v41 offset:1280
    ds_read_b64_tr_b16 v[116:117], v41 offset:32
    ds_read_b64_tr_b16 v[118:119], v41 offset:1312
    ds_read_b64_tr_b16 v[132:133], v41 offset:64
    ds_read_b64_tr_b16 v[134:135], v41 offset:1344
    ds_read_b64_tr_b16 v[148:149], v41 offset:96
    ds_read_b64_tr_b16 v[150:151], v41 offset:1376
    ds_read_b64_tr_b16 v[164:165], v41 offset:128
    ds_read_b64_tr_b16 v[166:167], v41 offset:1408
    ds_read_b64_tr_b16 v[180:181], v41 offset:160
    ds_read_b64_tr_b16 v[182:183], v41 offset:1440
    s_waitcnt lgkmcnt(4)
    ds_read_b64_tr_b16 v[196:197], v41 offset:192
    ds_read_b64_tr_b16 v[198:199], v41 offset:1472
    ds_read_b64_tr_b16 v[212:213], v41 offset:224
    ds_read_b64_tr_b16 v[214:215], v41 offset:1504
    ds_read_b64_tr_b16 v[228:229], v41 offset:256
    ds_read_b64_tr_b16 v[230:231], v41 offset:1536
    ds_read_b64_tr_b16 v[244:245], v41 offset:288
    ds_read_b64_tr_b16 v[246:247], v41 offset:1568
    s_waitcnt lgkmcnt(0)
    s_mov_b32 s66, s62
    s_bfm_b32 s61, s4, 0
    s_and_b32 s61, s61, 0x15
    s_bcnt1_i32_b32 s61, s61
    s_cmp_eq_u32 s70, 0
    s_cbranch_scc1 L_pf_done2
    s_cmp_eq_u32 s70, 3
    s_cbranch_scc1 L_pf_wd2
    s_cmp_eq_u32 s70, 1
    s_cselect_b32 s24, s48, s50
    s_cselect_b32 s25, s49, s51
    s_mov_b32 s26, 2211840
    s_mov_b32 s27, 0x20000
    s_mul_i32 s62, s4, 384
    s_lshl_b32 s63, s61, 7
    s_add_u32 s62, s62, s63
    s_mul_i32 s63, s5, 69120
    s_add_u32 s62, s62, s63
    v_lshrrev_b32 v20, 3, v1
    v_mul_u32_u24 v20, 3456, v20
    v_and_b32 v21, 7, v1
    v_lshl_add_u32 v20, v21, 6, v20
    s_lshr_b32 s63, s95, 1
    v_cmp_gt_u32 vcc, s63, v21
    v_mov_b32 v22, 0x7ffffff0
    s_nop 0
    v_cndmask_b32 v20, v22, v20, vcc
    v_cmp_gt_u32 vcc, 32, v1
    buffer_load_dword v24, v20, s[24:27], s62 offen
    s_add_u32 s62, s62, 27648
    buffer_load_dword v25, v20, s[24:27], s62 offen
    s_add_u32 s62, s62, 27648
    v_cndmask_b32 v23, v22, v20, vcc
    buffer_load_dword v26, v23, s[24:27], s62 offen
    s_branch L_pf_done2
L_pf_wd2:
    s_cmp_eq_u32 s95, 16
    s_cbranch_scc1 L_pf_done2
    s_sub_u32 s62, s4, s61
    s_lshl_b32 s62, s62, 8
    s_mul_i32 s63, s5, 69120
    s_add_u32 s62, s62, s63
    s_mov_b32 s24, s52
    s_mov_b32 s25, s53
    s_mov_b32 s26, 2211840
    s_mov_b32 s27, 0x20000
    v_lshrrev_b32 v20, 2, v1
    v_mul_u32_u24 v20, 1280, v20
    v_and_b32 v21, 3, v1
    v_lshl_add_u32 v20, v21, 6, v20
    v_cmp_gt_u32 vcc, 24, v1
    v_mov_b32 v22, 0x7ffffff0
    buffer_load_dword v24, v20, s[24:27], s62 offen
    s_add_u32 s62, s62, 20480
    buffer_load_dword v25, v20, s[24:27], s62 offen
    s_add_u32 s62, s62, 20480
    buffer_load_dword v26, v20, s[24:27], s62 offen
    s_add_u32 s62, s62, 20480
    v_cndmask_b32 v23, v22, v20, vcc
    buffer_load_dword v27, v23, s[24:27], s62 offen
L_pf_done2:
    s_mov_b32 s62, s66
    s_add_u32 m0, s62, 0
    s_nop 0
    buffer_load_dwordx4 v36, s[12:15], s65 offen  lds
    s_waitcnt vmcnt(1)
    s_add_u32 m0, s62, 1024
    s_nop 0
    buffer_load_dwordx4 v37, s[12:15], s65 offen  lds
    s_waitcnt vmcnt(1)
    s_add_u32 m0, s62, 2048
    s_nop 0
    buffer_load_dwordx4 v38, s[12:15], s65 offen  lds
    s_waitcnt vmcnt(1)
    s_add_u32 m0, s62, 3072
    s_nop 0
    buffer_load_dwordx4 v39, s[12:15], s65 offen  lds
    s_waitcnt vmcnt(1)
    s_add_u32 m0, s62, 4096
    s_nop 0
    buffer_load_dwordx4 v40, s[12:15], s65 offen  lds
    s_waitcnt vmcnt(1)
    s_add_u32 m0, s62, 5120
    s_add_u32 s65, s65, 20480
    buffer_load_dwordx4 v36, s[12:15], s65 offen  lds
    s_waitcnt vmcnt(1)
    s_add_u32 m0, s62, 6144
    s_nop 0
    buffer_load_dwordx4 v37, s[12:15], s65 offen  lds
    s_waitcnt vmcnt(1)
    s_add_u32 m0, s62, 7168
    s_nop 0
    buffer_load_dwordx4 v38, s[12:15], s65 offen  lds
    s_waitcnt vmcnt(1)
    s_add_u32 m0, s62, 8192
    s_nop 0
    buffer_load_dwordx4 v39, s[12:15], s65 offen  lds
    s_waitcnt vmcnt(1)
    s_add_u32 m0, s62, 9216
    s_nop 0
    buffer_load_dwordx4 v40, s[12:15], s65 offen  lds
    s_waitcnt vmcnt(1)
    s_add_u32 s65, s65, 20480
    s_waitcnt vmcnt(0)
    ds_read_b64_tr_b16 v[104:105], v41 offset:0
    ds_read_b64_tr_b16 v[106:107], v41 offset:1280
    ds_read_b64_tr_b16 v[120:121], v41 offset:32
    ds_read_b64_tr_b16 v[122:123], v41 offset:1312
    ds_read_b64_tr_b16 v[136:137], v41 offset:64
    ds_read_b64_tr_b16 v[138:139], v41 offset:1344
    ds_read_b64_tr_b16 v[152:153], v41 offset:96
    ds_read_b64_tr_b16 v[154:155], v41 offset:1376
    ds_read_b64_tr_b16 v[168:169], v41 offset:128
    ds_read_b64_tr_b16 v[170:171], v41 offset:1408
    ds_read_b64_tr_b16 v[184:185], v41 offset:160
    ds_read_b64_tr_b16 v[186:187], v41 offset:1440
    s_waitcnt lgkmcnt(4)
    ds_read_b64_tr_b16 v[200:201], v41 offset:192
    ds_read_b64_tr_b16 v[202:203], v41 offset:1472
    ds_read_b64_tr_b16 v[216:217], v41 offset:224
    ds_read_b64_tr_b16 v[218:219], v41 offset:1504
    ds_read_b64_tr_b16 v[232:233], v41 offset:256
    ds_read_b64_tr_b16 v[234:235], v41 offset:1536
    ds_read_b64_tr_b16 v[248:249], v41 offset:288
    ds_read_b64_tr_b16 v[250:251], v41 offset:1568
    s_waitcnt lgkmcnt(0)
    s_add_u32 m0, s62, 0
    s_nop 0
    buffer_load_dwordx4 v36, s[12:15], s65 offen  lds
    s_waitcnt vmcnt(1)
    s_add_u32 m0, s62, 1024
    s_nop 0
    buffer_load_dwordx4 v37, s[12:15], s65 offen  lds
    s_waitcnt vmcnt(1)
    s_add_u32 m0, s62, 2048
    s_nop 0
    buffer_load_dwordx4 v38, s[12:15], s65 offen  lds
    s_waitcnt vmcnt(1)
    s_add_u32 m0, s62, 3072
    s_nop 0
    buffer_load_dwordx4 v39, s[12:15], s65 offen  lds
    s_waitcnt vmcnt(1)
    s_add_u32 m0, s62, 4096
    s_nop 0
    buffer_load_dwordx4 v40, s[12:15], s65 offen  lds
    s_waitcnt vmcnt(1)
    s_add_u32 m0, s62, 5120
    s_add_u32 s65, s65, 20480
    buffer_load_dwordx4 v36, s[12:15], s65 offen  lds
    s_waitcnt vmcnt(1)
    s_add_u32 m0, s62, 6144
    s_nop 0
    buffer_load_dwordx4 v37, s[12:15], s65 offen  lds
    s_waitcnt vmcnt(1)
    s_add_u32 m0, s62, 7168
    s_nop 0
    buffer_load_dwordx4 v38, s[12:15], s65 offen  lds
    s_waitcnt vmcnt(1)
    s_add_u32 m0, s62, 8192
    s_nop 0
    buffer_load_dwordx4 v39, s[12:15], s65 offen  lds
    s_waitcnt vmcnt(1)
    s_add_u32 m0, s62, 9216
    s_nop 0
    buffer_load_dwordx4 v40, s[12:15], s65 offen  lds
    s_waitcnt vmcnt(1)
    s_add_u32 s65, s65, 20480
    s_waitcnt vmcnt(0)
    ds_read_b64_tr_b16 v[108:109], v41 offset:0
    ds_read_b64_tr_b16 v[110:111], v41 offset:1280
    ds_read_b64_tr_b16 v[124:125], v41 offset:32
    ds_read_b64_tr_b16 v[126:127], v41 offset:1312
    ds_read_b64_tr_b16 v[140:141], v41 offset:64
    ds_read_b64_tr_b16 v[142:143], v41 offset:1344
    ds_read_b64_tr_b16 v[156:157], v41 offset:96
    ds_read_b64_tr_b16 v[158:159], v41 offset:1376
    ds_read_b64_tr_b16 v[172:173], v41 offset:128
    ds_read_b64_tr_b16 v[174:175], v41 offset:1408
    ds_read_b64_tr_b16 v[188:189], v41 offset:160
    ds_read_b64_tr_b16 v[190:191], v41 offset:1440
    s_waitcnt lgkmcnt(4)
    ds_read_b64_tr_b16 v[204:205], v41 offset:192
    ds_read_b64_tr_b16 v[206:207], v41 offset:1472
    ds_read_b64_tr_b16 v[220:221], v41 offset:224
    ds_read_b64_tr_b16 v[222:223], v41 offset:1504
    ds_read_b64_tr_b16 v[236:237], v41 offset:256
    ds_read_b64_tr_b16 v[238:239], v41 offset:1536
    ds_read_b64_tr_b16 v[252:253], v41 offset:288
    ds_read_b64_tr_b16 v[254:255], v41 offset:1568
    s_waitcnt lgkmcnt(0)
    s_cmp_lg_u32 s70, 1
    s_cbranch_scc1 L_noctl
    s_lshl_b32 s61, s4, 7
    v_and_b32 v30, 31, v1
    v_lshl_add_u32 v30, v30, 2, s61
    v_lshrrev_b32 v31, 5, v1
    v_lshl_add_u32 v30, v31, 10, v30
    s_lshl_b32 s62, s5, 2
    s_add_u32 s61, s61, s62
    v_mov_b32 v31, s61
    v_mov_b32 v32, s74
    v_mov_b32 v33, 0
    s_mov_b32 s65, 851968
    s_mov_b32 s66, 88
L_cw:
    s_sleep 2
    ds_read_b32 v34, v33 offset:19536
    s_waitcnt lgkmcnt(0)
    v_readfirstlane_b32 s62, v34
    s_nop 0
    s_cmp_gt_u32 s62, s66
    s_cbranch_scc1 L_cw
    s_mov_b64 exec, 1
    buffer_store_dword v32, v31, s[16:19], s65 offen
    s_mov_b64 exec, -1
    buffer_load_dword v34, v30, s[16:19], s65 offen sc1
    s_waitcnt vmcnt(0)
    v_cmp_eq_u32 vcc, s74, v34
    s_mov_b32 s63, 0
    s_mov_b32 s61, 0
    s_bcnt1_i32_b32 s62, vcc_lo
    s_bitcmp1_b32 0xf0, s4
    s_cselect_b32 s67, 6, 0
    s_add_u32 s62, s62, s67
    s_cmp_ge_u32 s62, 12
    s_cselect_b32 s63, 1, s63
    s_cmp_ge_u32 s62, 24
    s_cselect_b32 s63, 2, s63
    s_cmp_ge_u32 s62, 32
    s_cselect_b32 s63, 3, s63
    s_cmp_ge_u32 s62, 0
    s_cselect_b32 s61, 1, s61
    s_cmp_ge_u32 s62, 46
    s_cselect_b32 s61, 2, s61
    s_cmp_ge_u32 s62, 46
    s_cselect_b32 s61, 3, s61
    s_cmp_gt_u32 s66, 62
    s_cselect_b32 s63, s61, s63
    s_bcnt1_i32_b32 s62, vcc_hi
    s_cmp_ge_u32 s62, 4
    s_cselect_b32 s63, 4, s63
    s_cmp_ge_u32 s62, 16
    s_cselect_b32 s63, 5, s63
    v_mov_b32 v34, s63
    ds_write_b32 v33, v34 offset:19540
    s_add_u32 s65, s65, 1024
    s_sub_u32 s66, s66, 4
    s_cmp_ge_i32 s66, 14
    s_cbranch_scc1 L_cw
    s_waitcnt lgkmcnt(0)
L_noctl:
    s_cmp_lg_u32 s70, 2
    s_cbranch_scc1 L_nosum
    v_mov_b32 v30, 0
L_mw:
    s_sleep 8
    ds_read_b128 v[20:23], v30 offset:19456
    s_waitcnt lgkmcnt(0)
    v_max3_u32 v24, v20, v21, v22
    v_max_u32 v24, v24, v23
    v_cmp_eq_u32 vcc, -1, v24
    s_nop 1
    s_cbranch_vccnz L_mw
    v_lshlrev_b32 v31, 5, v1
    ds_read_b128 v[36:39], v31 offset:23392
    ds_read_b128 v[40:43], v31 offset:23408
    ds_read_b128 v[44:47], v31 offset:25696
    ds_read_b128 v[48:51], v31 offset:25712
    ds_read_b128 v[52:55], v31 offset:28000
    ds_read_b128 v[56:59], v31 offset:28016
    ds_read_b128 v[60:63], v31 offset:30304
    ds_read_b128 v[64:67], v31 offset:30320
    v_max3_f32 v28, v20, v21, v22
    v_max_f32 v28, v28, v23
    v_mul_f32 v24, s68, v28
    v_mov_b32 v29, 0
    v_mov_b32 v25, 0
    s_waitcnt lgkmcnt(0)
    v_lshlrev_b32 v26, 16, v36
    v_and_b32 v27, 0xffff0000, v36
    v_fma_f32 v26, v26, s68, -v24
    v_fma_f32 v27, v27, s68, -v24
    v_exp_f32 v26, v26
    v_exp_f32 v27, v27
    v_add_f32 v29, v29, v26
    v_add_f32 v25, v25, v27
    v_lshlrev_b32 v26, 16, v37
    v_and_b32 v27, 0xffff0000, v37
    v_fma_f32 v26, v26, s68, -v24
    v_fma_f32 v27, v27, s68, -v24
    v_exp_f32 v26, v26
    v_exp_f32 v27, v27
    v_add_f32 v29, v29, v26
    v_add_f32 v25, v25, v27
    v_lshlrev_b32 v26, 16, v38
    v_and_b32 v27, 0xffff0000, v38
    v_fma_f32 v26, v26, s68, -v24
    v_fma_f32 v27, v27, s68, -v24
    v_exp_f32 v26, v26
    v_exp_f32 v27, v27
    v_add_f32 v29, v29, v26
    v_add_f32 v25, v25, v27
    v_lshlrev_b32 v26, 16, v39
    v_and_b32 v27, 0xffff0000, v39
    v_fma_f32 v26, v26, s68, -v24
    v_fma_f32 v27, v27, s68, -v24
    v_exp_f32 v26, v26
    v_exp_f32 v27, v27
    v_add_f32 v29, v29, v26
    v_add_f32 v25, v25, v27
    v_lshlrev_b32 v26, 16, v40
    v_and_b32 v27, 0xffff0000, v40
    v_fma_f32 v26, v26, s68, -v24
    v_fma_f32 v27, v27, s68, -v24
    v_exp_f32 v26, v26
    v_exp_f32 v27, v27
    v_add_f32 v29, v29, v26
    v_add_f32 v25, v25, v27
    v_lshlrev_b32 v26, 16, v41
    v_and_b32 v27, 0xffff0000, v41
    v_fma_f32 v26, v26, s68, -v24
    v_fma_f32 v27, v27, s68, -v24
    v_exp_f32 v26, v26
    v_exp_f32 v27, v27
    v_add_f32 v29, v29, v26
    v_add_f32 v25, v25, v27
    v_lshlrev_b32 v26, 16, v42
    v_and_b32 v27, 0xffff0000, v42
    v_fma_f32 v26, v26, s68, -v24
    v_fma_f32 v27, v27, s68, -v24
    v_exp_f32 v26, v26
    v_exp_f32 v27, v27
    v_add_f32 v29, v29, v26
    v_add_f32 v25, v25, v27
    v_lshlrev_b32 v26, 16, v43
    v_and_b32 v27, 0xffff0000, v43
    v_fma_f32 v26, v26, s68, -v24
    v_fma_f32 v27, v27, s68, -v24
    v_exp_f32 v26, v26
    v_exp_f32 v27, v27
    v_add_f32 v29, v29, v26
    v_add_f32 v25, v25, v27
    v_lshlrev_b32 v26, 16, v44
    v_and_b32 v27, 0xffff0000, v44
    v_fma_f32 v26, v26, s68, -v24
    v_fma_f32 v27, v27, s68, -v24
    v_exp_f32 v26, v26
    v_exp_f32 v27, v27
    v_add_f32 v29, v29, v26
    v_add_f32 v25, v25, v27
    v_lshlrev_b32 v26, 16, v45
    v_and_b32 v27, 0xffff0000, v45
    v_fma_f32 v26, v26, s68, -v24
    v_fma_f32 v27, v27, s68, -v24
    v_exp_f32 v26, v26
    v_exp_f32 v27, v27
    v_add_f32 v29, v29, v26
    v_add_f32 v25, v25, v27
    v_lshlrev_b32 v26, 16, v46
    v_and_b32 v27, 0xffff0000, v46
    v_fma_f32 v26, v26, s68, -v24
    v_fma_f32 v27, v27, s68, -v24
    v_exp_f32 v26, v26
    v_exp_f32 v27, v27
    v_add_f32 v29, v29, v26
    v_add_f32 v25, v25, v27
    v_lshlrev_b32 v26, 16, v47
    v_and_b32 v27, 0xffff0000, v47
    v_fma_f32 v26, v26, s68, -v24
    v_fma_f32 v27, v27, s68, -v24
    v_exp_f32 v26, v26
    v_exp_f32 v27, v27
    v_add_f32 v29, v29, v26
    v_add_f32 v25, v25, v27
    v_lshlrev_b32 v26, 16, v48
    v_and_b32 v27, 0xffff0000, v48
    v_fma_f32 v26, v26, s68, -v24
    v_fma_f32 v27, v27, s68, -v24
    v_exp_f32 v26, v26
    v_exp_f32 v27, v27
    v_add_f32 v29, v29, v26
    v_add_f32 v25, v25, v27
    v_lshlrev_b32 v26, 16, v49
    v_and_b32 v27, 0xffff0000, v49
    v_fma_f32 v26, v26, s68, -v24
    v_fma_f32 v27, v27, s68, -v24
    v_exp_f32 v26, v26
    v_exp_f32 v27, v27
    v_add_f32 v29, v29, v26
    v_add_f32 v25, v25, v27
    v_lshlrev_b32 v26, 16, v50
    v_and_b32 v27, 0xffff0000, v50
    v_fma_f32 v26, v26, s68, -v24
    v_fma_f32 v27, v27, s68, -v24
    v_exp_f32 v26, v26
    v_exp_f32 v27, v27
    v_add_f32 v29, v29, v26
    v_add_f32 v25, v25, v27
    v_lshlrev_b32 v26, 16, v51
    v_and_b32 v27, 0xffff0000, v51
    v_fma_f32 v26, v26, s68, -v24
    v_fma_f32 v27, v27, s68, -v24
    v_exp_f32 v26, v26
    v_exp_f32 v27, v27
    v_add_f32 v29, v29, v26
    v_add_f32 v25, v25, v27
    v_lshlrev_b32 v26, 16, v52
    v_and_b32 v27, 0xffff0000, v52
    v_fma_f32 v26, v26, s68, -v24
    v_fma_f32 v27, v27, s68, -v24
    v_exp_f32 v26, v26
    v_exp_f32 v27, v27
    v_add_f32 v29, v29, v26
    v_add_f32 v25, v25, v27
    v_lshlrev_b32 v26, 16, v53
    v_and_b32 v27, 0xffff0000, v53
    v_fma_f32 v26, v26, s68, -v24
    v_fma_f32 v27, v27, s68, -v24
    v_exp_f32 v26, v26
    v_exp_f32 v27, v27
    v_add_f32 v29, v29, v26
    v_add_f32 v25, v25, v27
    v_lshlrev_b32 v26, 16, v54
    v_and_b32 v27, 0xffff0000, v54
    v_fma_f32 v26, v26, s68, -v24
    v_fma_f32 v27, v27, s68, -v24
    v_exp_f32 v26, v26
    v_exp_f32 v27, v27
    v_add_f32 v29, v29, v26
    v_add_f32 v25, v25, v27
    v_lshlrev_b32 v26, 16, v55
    v_and_b32 v27, 0xffff0000, v55
    v_fma_f32 v26, v26, s68, -v24
    v_fma_f32 v27, v27, s68, -v24
    v_exp_f32 v26, v26
    v_exp_f32 v27, v27
    v_add_f32 v29, v29, v26
    v_add_f32 v25, v25, v27
    v_lshlrev_b32 v26, 16, v56
    v_and_b32 v27, 0xffff0000, v56
    v_fma_f32 v26, v26, s68, -v24
    v_fma_f32 v27, v27, s68, -v24
    v_exp_f32 v26, v26
    v_exp_f32 v27, v27
    v_add_f32 v29, v29, v26
    v_add_f32 v25, v25, v27
    v_lshlrev_b32 v26, 16, v57
    v_and_b32 v27, 0xffff0000, v57
    v_fma_f32 v26, v26, s68, -v24
    v_fma_f32 v27, v27, s68, -v24
    v_exp_f32 v26, v26
    v_exp_f32 v27, v27
    v_add_f32 v29, v29, v26
    v_add_f32 v25, v25, v27
    v_lshlrev_b32 v26, 16, v58
    v_and_b32 v27, 0xffff0000, v58
    v_fma_f32 v26, v26, s68, -v24
    v_fma_f32 v27, v27, s68, -v24
    v_exp_f32 v26, v26
    v_exp_f32 v27, v27
    v_add_f32 v29, v29, v26
    v_add_f32 v25, v25, v27
    v_lshlrev_b32 v26, 16, v59
    v_and_b32 v27, 0xffff0000, v59
    v_fma_f32 v26, v26, s68, -v24
    v_fma_f32 v27, v27, s68, -v24
    v_exp_f32 v26, v26
    v_exp_f32 v27, v27
    v_add_f32 v29, v29, v26
    v_add_f32 v25, v25, v27
    v_lshlrev_b32 v26, 16, v60
    v_and_b32 v27, 0xffff0000, v60
    v_fma_f32 v26, v26, s68, -v24
    v_fma_f32 v27, v27, s68, -v24
    v_exp_f32 v26, v26
    v_exp_f32 v27, v27
    v_add_f32 v29, v29, v26
    v_add_f32 v25, v25, v27
    v_lshlrev_b32 v26, 16, v61
    v_and_b32 v27, 0xffff0000, v61
    v_fma_f32 v26, v26, s68, -v24
    v_fma_f32 v27, v27, s68, -v24
    v_exp_f32 v26, v26
    v_exp_f32 v27, v27
    v_add_f32 v29, v29, v26
    v_add_f32 v25, v25, v27
    v_lshlrev_b32 v26, 16, v62
    v_and_b32 v27, 0xffff0000, v62
    v_fma_f32 v26, v26, s68, -v24
    v_fma_f32 v27, v27, s68, -v24
    v_exp_f32 v26, v26
    v_exp_f32 v27, v27
    v_add_f32 v29, v29, v26
    v_add_f32 v25, v25, v27
    v_lshlrev_b32 v26, 16, v63
    v_and_b32 v27, 0xffff0000, v63
    v_fma_f32 v26, v26, s68, -v24
    v_fma_f32 v27, v27, s68, -v24
    v_exp_f32 v26, v26
    v_exp_f32 v27, v27
    v_add_f32 v29, v29, v26
    v_add_f32 v25, v25, v27
    v_lshlrev_b32 v26, 16, v64
    v_and_b32 v27, 0xffff0000, v64
    v_fma_f32 v26, v26, s68, -v24
    v_fma_f32 v27, v27, s68, -v24
    v_exp_f32 v26, v26
    v_exp_f32 v27, v27
    v_add_f32 v29, v29, v26
    v_add_f32 v25, v25, v27
    v_lshlrev_b32 v26, 16, v65
    v_and_b32 v27, 0xffff0000, v65
    v_fma_f32 v26, v26, s68, -v24
    v_fma_f32 v27, v27, s68, -v24
    v_exp_f32 v26, v26
    v_exp_f32 v27, v27
    v_add_f32 v29, v29, v26
    v_add_f32 v25, v25, v27
    v_lshlrev_b32 v26, 16, v66
    v_and_b32 v27, 0xffff0000, v66
    v_fma_f32 v26, v26, s68, -v24
    v_fma_f32 v27, v27, s68, -v24
    v_exp_f32 v26, v26
    v_exp_f32 v27, v27
    v_add_f32 v29, v29, v26
    v_add_f32 v25, v25, v27
    v_lshlrev_b32 v26, 16, v67
    v_and_b32 v27, 0xffff0000, v67
    v_fma_f32 v26, v26, s68, -v24
    v_fma_f32 v27, v27, s68, -v24
    v_exp_f32 v26, v26
    v_exp_f32 v27, v27
    v_add_f32 v29, v29, v26
    v_add_f32 v25, v25, v27
    v_add_f32 v29, v29, v25
    s_nop 1
    v_add_f32_dpp v29, v29, v29 row_shr:1 row_mask:0xf bank_mask:0xf bound_ctrl:0
    s_nop 1
    v_add_f32_dpp v29, v29, v29 row_shr:2 row_mask:0xf bank_mask:0xf bound_ctrl:0
    s_nop 1
    v_add_f32_dpp v29, v29, v29 row_shr:4 row_mask:0xf bank_mask:0xf bound_ctrl:0
    s_nop 1
    v_add_f32_dpp v29, v29, v29 row_shr:8 row_mask:0xf bank_mask:0xf bound_ctrl:0
    s_nop 1
    v_add_f32_dpp v29, v29, v29 row_bcast:15 row_mask:0xa bank_mask:0xf
    s_nop 1
    v_add_f32_dpp v29, v29, v29 row_bcast:31 row_mask:0xc bank_mask:0xf
    s_nop 0
    v_readlane_b32 s61, v29, 63
    s_nop 1
    v_mov_b32 v29, s61
    v_min_u32 v29, -2, v29
L_flg2:
    ds_read_b32 v20, v30 offset:19532
    s_waitcnt lgkmcnt(0)
    v_cmp_ne_u32 vcc, 1, v20
    s_nop 1
    s_cbranch_vccnz L_flg2
    s_mov_b64 exec, 1
    buffer_store_dwordx2 v[28:29], v12, s[16:19], 0 offen sc1
    s_mov_b64 exec, -1
L_nosum:
    s_cmp_lg_u32 s70, 0
    s_cbranch_scc1 L_idle
    s_cmp_eq_u32 s75, 255
    s_cbranch_scc1 L_idle
    s_cmp_ge_u32 s75, 128
    s_cbranch_scc1 L_f2
    s_lshl_b32 s61, s75, 5
    s_mov_b32 s24, s48
    s_mov_b32 s25, s49
    s_mov_b32 s26, 2211840
    s_mov_b32 s27, 0x20000
    s_mov_b32 s28, s50
    s_mov_b32 s29, s51
    s_mov_b32 s30, 2211840
    s_mov_b32 s31, 0x20000
    v_lshrrev_b32 v30, 1, v1
    v_mul_u32_u24 v30, 3456, v30
    v_and_b32 v31, 1, v1
    v_lshl_add_u32 v30, v31, 4, v30
    v_add_u32 v30, s61, v30
    s_mov_b32 s65, 0
    s_mov_b32 s62, 73568
    s_mov_b32 s66, 20
L_f1_ld:
    s_mov_b32 m0, s62
    s_add_u32 s63, s62, 20480
    buffer_load_dwordx4 v30, s[24:27], s65 offen  lds
    s_waitcnt vmcnt(3)
    s_mov_b32 m0, s63
    s_add_u32 s62, s62, 1024
    buffer_load_dwordx4 v30, s[28:31], s65 offen  lds
    s_add_u32 s65, s65, 110592
    s_waitcnt vmcnt(3)
    s_sub_u32 s66, s66, 1
    s_cmp_lg_u32 s66, 0
    s_cbranch_scc1 L_f1_ld
    v_lshrrev_b32 v31, 2, v2
    v_lshl_add_u32 v31, v3, 3, v31
    v_lshlrev_b32 v14, 5, v31
    v_and_b32 v31, 3, v1
    v_lshl_add_u32 v14, v31, 3, v14
    v_add_u32 v14, 73568, v14
    v_mul_u32_u24 v15, 1280, v31
    v_lshl_add_u32 v15, v3, 4, v15
    v_add_u32 v15, 10240, v15
    v_mov_b32 v28, 0
    v_mov_b32 v32, 0
    v_mov_b32 v29, 0
    v_mov_b32 v33, 0
    v_mov_b32 v30, 0
    v_mov_b32 v34, 0
    v_mov_b32 v31, 0
    v_mov_b32 v35, 0
    s_mov_b32 s66, 20
    s_waitcnt vmcnt(0)
L_f1_mm:
    ds_read_b128 v[20:23], v15
    ds_read_b64_tr_b16 v[24:25], v14
    ds_read_b64_tr_b16 v[26:27], v14 offset:128
    ds_read_b64_tr_b16 v[36:37], v14 offset:20480
    ds_read_b64_tr_b16 v[38:39], v14 offset:20608
    v_add_u32 v15, 64, v15
    v_add_u32 v14, 1024, v14
    s_waitcnt lgkmcnt(0)
    v_mfma_f32_16x16x32_bf16 v[28:31], v[20:23], v[24:27], v[28:31]
    v_mfma_f32_16x16x32_bf16 v[32:35], v[20:23], v[36:39], v[32:35]
    s_sub_u32 s66, s66, 1
    s_cmp_lg_u32 s66, 0
    s_cbranch_scc1 L_f1_mm
    s_nop 7
    v_cmp_eq_u32 vcc, 1, v3
    s_nop 1
    v_cndmask_b32 v28, v28, v29, vcc
    v_cndmask_b32 v32, v32, v33, vcc
    v_cmp_eq_u32 vcc, 2, v3
    s_nop 1
    v_cndmask_b32 v28, v28, v30, vcc
    v_cndmask_b32 v32, v32, v34, vcc
    v_cmp_eq_u32 vcc, 3, v3
    s_nop 1
    v_cndmask_b32 v28, v28, v31, vcc
    v_cndmask_b32 v32, v32, v35, vcc
    v_cvt_pk_bf16_f32 v28, v28, v28
    v_cvt_pk_bf16_f32 v32, v32, v32
    v_and_b32 v28, 0xffff0000, v28
    v_and_b32 v32, 0xffff0000, v32
    s_mov_b32 s61, 0x3d372713
    s_mov_b32 s62, 0xc0135761
    v_mul_f32 v20, v28, v28
    v_fma_f32 v20, v20, s61, 1.0
    v_mul_f32 v20, v20, v28
    v_mul_f32 v20, s62, v20
    v_exp_f32 v20, v20
    s_nop 0
    v_add_f32 v20, 1.0, v20
    v_rcp_f32 v20, v20
    s_nop 0
    v_mul_f32 v20, v20, v28
    v_cvt_pk_bf16_f32 v20, v20, v20
    v_and_b32 v20, 0xffff0000, v20
    v_mul_f32 v20, v20, v32
    s_lshl_b32 s61, s75, 8
    s_add_u32 s61, s61, 720896
    v_mov_b32_dpp v24, v20 quad_perm:[1,0,3,2] row_mask:0xf bank_mask:0xf
    v_cvt_pk_bf16_f32 v20, v20, v24
    v_mov_b32 v21, s74
    s_mov_b32 exec_lo, 0x55555555
    s_mov_b32 exec_hi, 0x55555555
    buffer_store_dwordx2 v[20:21], v10, s[16:19], s61 offen sc1
    s_mov_b64 exec, -1
    s_branch L_idle
L_f2:
    s_sub_u32 s64, s75, 128
    s_and_b32 s71, s64, 3
    s_mul_i32 s67, s71, 14
    s_cmp_eq_u32 s71, 3
    s_cselect_b32 s67, 41, s67
    s_lshr_b32 s69, s71, 1
    s_sub_u32 s69, 14, s69
    s_mov_b32 s24, s52
    s_mov_b32 s25, s53
    s_mov_b32 s26, 2211840
    s_mov_b32 s27, 0x20000
    s_lshr_b32 s61, s64, 2
    s_lshl_b32 s61, s61, 7
    v_lshrrev_b32 v30, 3, v1
    v_mul_u32_u24 v30, 1280, v30
    v_and_b32 v31, 7, v1
    v_lshl_add_u32 v30, v31, 4, v30
    v_add_u32 v30, s61, v30
    s_mul_i32 s65, s67, 40960
    s_mov_b32 s62, 73568
    s_lshl_b32 s66, s69, 2
L_f2_ld:
    s_mov_b32 m0, s62
    s_add_u32 s62, s62, 1024
    buffer_load_dwordx4 v30, s[24:27], s65 offen  lds
    s_add_u32 s65, s65, 10240
    s_waitcnt vmcnt(3)
    s_sub_u32 s66, s66, 1
    s_cmp_lg_u32 s66, 0
    s_cbranch_scc1 L_f2_ld
    s_lshl_b32 s61, s67, 1
    s_min_u32 s62, s61, 80
    s_sub_u32 s63, s61, s62
    s_lshl_b32 s63, s63, 5
    s_lshl_b32 s62, s62, 8
    s_add_u32 s62, s62, 720896
    s_lshl_b32 s61, s71, 13
    s_add_u32 s61, s61, 671744
    v_lshlrev_b32 v30, 4, v1
    v_lshlrev_b32 v31, 7, v1
    v_lshrrev_b32 v32, 2, v2
    v_mul_u32_u24 v32, 896, v32
    v_lshl_add_u32 v32, v3, 5, v32
    v_and_b32 v33, 3, v1
    v_lshl_add_u32 v32, v33, 3, v32
    s_add_u32 s65, s62, 4096
    s_branch L_g
L_gr:
    s_cmp_eq_u32 s94, 0
    s_cbranch_scc1 L_gr_x
    s_sub_u32 s94, s94, 1
    s_sleep 127
L_g:
    buffer_load_dwordx4 v[36:39], v30, s[16:19], s62 offen offset:0 sc1
    buffer_load_dwordx4 v[40:43], v30, s[16:19], s62 offen offset:1024 sc1
    buffer_load_dwordx4 v[44:47], v30, s[16:19], s62 offen offset:2048 sc1
    buffer_load_dwordx4 v[48:51], v30, s[16:19], s62 offen offset:3072 sc1
    buffer_load_dwordx4 v[52:55], v30, s[16:19], s65 offen offset:0 sc1
    buffer_load_dwordx4 v[56:59], v30, s[16:19], s65 offen offset:1024 sc1
    buffer_load_dwordx4 v[60:63], v30, s[16:19], s65 offen offset:2048 sc1
    buffer_load_dword v64, v31, s[16:19], s61 offen sc1
    s_waitcnt vmcnt(0)
    v_xor_b32 v64, s74, v64
    v_xor_b32 v37, s74, v37
    v_xor_b32 v39, s74, v39
    v_or3_b32 v64, v64, v37, v39
    v_xor_b32 v41, s74, v41
    v_xor_b32 v43, s74, v43
    v_or3_b32 v64, v64, v41, v43
    v_xor_b32 v45, s74, v45
    v_xor_b32 v47, s74, v47
    v_or3_b32 v64, v64, v45, v47
    v_xor_b32 v49, s74, v49
    v_xor_b32 v51, s74, v51
    v_or3_b32 v64, v64, v49, v51
    v_xor_b32 v53, s74, v53
    v_xor_b32 v55, s74, v55
    v_or3_b32 v64, v64, v53, v55
    v_xor_b32 v57, s74, v57
    v_xor_b32 v59, s74, v59
    v_or3_b32 v64, v64, v57, v59
    v_xor_b32 v61, s74, v61
    v_xor_b32 v63, s74, v63
    v_or3_b32 v64, v64, v61, v63
    v_cmp_ne_u32 vcc, 0, v64
    s_nop 1
    s_cbranch_vccnz L_gr
L_gr_x:
    v_mov_b32 v37, v38
    ds_write_b64 v32, v[36:37] offset:19808
    v_mov_b32 v41, v42
    ds_write_b64 v32, v[40:41] offset:19936
    v_mov_b32 v45, v46
    ds_write_b64 v32, v[44:45] offset:20064
    v_mov_b32 v49, v50
    ds_write_b64 v32, v[48:49] offset:20192
    v_mov_b32 v53, v54
    ds_write_b64 v32, v[52:53] offset:20320
    v_mov_b32 v57, v58
    ds_write_b64 v32, v[56:57] offset:20448
    v_mov_b32 v61, v62
    ds_write_b64 v32, v[60:61] offset:20576
    v_lshrrev_b32 v34, 2, v2
    v_lshl_add_u32 v34, v3, 3, v34
    v_lshlrev_b32 v14, 7, v34
    v_lshl_add_u32 v14, v33, 3, v14
    v_add_u32 v14, 73568, v14
    v_mul_u32_u24 v15, 896, v33
    v_lshl_add_u32 v15, v3, 4, v15
    v_add_u32 v15, s63, v15
    s_waitcnt lgkmcnt(0)
    v_mov_b32 v52, 0
    v_mov_b32 v53, 0
    v_mov_b32 v54, 0
    v_mov_b32 v55, 0
    v_mov_b32 v56, 0
    v_mov_b32 v57, 0
    v_mov_b32 v58, 0
    v_mov_b32 v59, 0
    v_mov_b32 v60, 0
    v_mov_b32 v61, 0
    v_mov_b32 v62, 0
    v_mov_b32 v63, 0
    v_mov_b32 v64, 0
    v_mov_b32 v65, 0
    v_mov_b32 v66, 0
    v_mov_b32 v67, 0
    s_mov_b32 s66, s69
L_f2_mm:
    ds_read_b128 v[20:23], v15 offset:19808
    ds_read_b64_tr_b16 v[36:37], v14 offset:0
    ds_read_b64_tr_b16 v[38:39], v14 offset:512
    ds_read_b64_tr_b16 v[40:41], v14 offset:32
    ds_read_b64_tr_b16 v[42:43], v14 offset:544
    ds_read_b64_tr_b16 v[44:45], v14 offset:64
    ds_read_b64_tr_b16 v[46:47], v14 offset:576
    ds_read_b64_tr_b16 v[48:49], v14 offset:96
    ds_read_b64_tr_b16 v[50:51], v14 offset:608
    v_add_u32 v15, 64, v15
    v_add_u32 v14, 4096, v14
    s_waitcnt lgkmcnt(0)
    v_mfma_f32_16x16x32_bf16 v[52:55], v[20:23], v[36:39], v[52:55]
    v_mfma_f32_16x16x32_bf16 v[56:59], v[20:23], v[40:43], v[56:59]
    v_mfma_f32_16x16x32_bf16 v[60:63], v[20:23], v[44:47], v[60:63]
    v_mfma_f32_16x16x32_bf16 v[64:67], v[20:23], v[48:51], v[64:67]
    s_sub_u32 s66, s66, 1
    s_cmp_lg_u32 s66, 0
    s_cbranch_scc1 L_f2_mm
    s_nop 7
    v_cmp_eq_u32 vcc, 1, v3
    s_nop 1
    v_cndmask_b32 v52, v52, v53, vcc
    v_cndmask_b32 v56, v56, v57, vcc
    v_cndmask_b32 v60, v60, v61, vcc
    v_cndmask_b32 v64, v64, v65, vcc
    v_cmp_eq_u32 vcc, 2, v3
    s_nop 1
    v_cndmask_b32 v52, v52, v54, vcc
    v_cndmask_b32 v56, v56, v58, vcc
    v_cndmask_b32 v60, v60, v62, vcc
    v_cndmask_b32 v64, v64, v66, vcc
    v_cmp_eq_u32 vcc, 3, v3
    s_nop 1
    v_cndmask_b32 v52, v52, v55, vcc
    v_cndmask_b32 v56, v56, v59, vcc
    v_cndmask_b32 v60, v60, v63, vcc
    v_cndmask_b32 v64, v64, v67, vcc
    v_mov_b32 v53, s74
    v_mov_b32 v57, s74
    v_mov_b32 v61, s74
    v_mov_b32 v65, s74
    v_lshlrev_b32 v30, 3, v1
    s_and_b32 s61, s64, 0xfc
    s_lshl_b32 s61, s61, 2
    s_add_u32 s61, s61, s71
    s_lshl_b32 s61, s61, 9
    s_add_u32 s61, s61, 753664
    buffer_store_dwordx2 v[52:53], v30, s[16:19], s61 offen sc1
    s_add_u32 s61, s61, 2048
    buffer_store_dwordx2 v[56:57], v30, s[16:19], s61 offen sc1
    s_add_u32 s61, s61, 2048
    buffer_store_dwordx2 v[60:61], v30, s[16:19], s61 offen sc1
    s_add_u32 s61, s61, 2048
    buffer_store_dwordx2 v[64:65], v30, s[16:19], s61 offen sc1
    s_add_u32 s61, s61, 2048
    s_lshl_b32 s61, s64, 11
    s_add_u32 s61, s61, 753664
    s_waitcnt vmcnt(0)
    s_branch L_p
L_pr:
    s_cmp_eq_u32 s94, 0
    s_cbranch_scc1 L_pr_x
    s_sub_u32 s94, s94, 1
    s_sleep 63
L_p:
    buffer_load_dwordx2 v[36:37], v30, s[16:19], s61 offen offset:0 sc1
    buffer_load_dwordx2 v[38:39], v30, s[16:19], s61 offen offset:512 sc1
    buffer_load_dwordx2 v[40:41], v30, s[16:19], s61 offen offset:1024 sc1
    buffer_load_dwordx2 v[42:43], v30, s[16:19], s61 offen offset:1536 sc1
    s_waitcnt vmcnt(0)
    v_xor_b32 v37, s74, v37
    v_xor_b32 v39, s74, v39
    v_xor_b32 v41, s74, v41
    v_xor_b32 v43, s74, v43
    v_or3_b32 v37, v37, v39, v41
    v_or_b32 v37, v37, v43
    v_cmp_ne_u32 vcc, 0, v37
    s_nop 1
    s_cbranch_vccnz L_pr
L_pr_x:
    s_cmp_lg_u32 s75, 128
    s_cbranch_scc1 L_noep
    v_mov_b32 v32, 0xac000
    v_mov_b32 v33, s74
    s_mov_b64 exec, 1
    buffer_store_dword v33, v32, s[16:19], 0 offen sc1
    s_mov_b64 exec, -1
L_noep:
    v_add_f32 v20, v36, v38
    v_add_f32 v21, v40, v42
    v_add_f32 v20, v20, v21
    v_cvt_pk_bf16_f32 v20, v20, v20
    v_and_b32 v20, 0xffff0000, v20
    s_mov_b32 s62, 0xbfb8aa3b
    v_mul_f32 v21, s62, v20
    v_exp_f32 v21, v21
    s_nop 0
    v_add_f32 v21, 1.0, v21
    v_rcp_f32 v21, v21
    s_nop 0
    v_mul_f32 v21, v21, v20
    v_cvt_pk_bf16_f32 v21, v21, v21
    v_and_b32 v21, 0xffff0000, v21
    ds_write_b32 v10, v21 offset:19552
    v_mov_b32 v20, 0
    v_mov_b32 v21, 1
    ds_write_b32 v20, v21 offset:19548
    s_waitcnt lgkmcnt(0)
L_idle:
    v_and_b32 v30, 3, v1
    v_lshlrev_b32 v30, 8, v30
    v_lshl_add_u32 v30, v3, 4, v30
    v_mov_b32 v31, 0
    s_lshl_b32 s61, s7, 5
    s_add_u32 s61, s61, s60
    s_lshl_b32 s61, s61, 1
    s_add_u32 s61, s61, s6
    s_lshl_b32 s61, s61, 6
    s_mul_i32 s62, s70, 163840
    s_add_u32 s61, s61, s62
    v_lshlrev_b32 v32, 14, v3
    v_lshl_add_u32 v32, v2, 2, v32
    v_add_u32 v32, s61, v32
    s_mov_b32 s66, 65536
    v_add_u32 v92, 131072, v32
    v_mov_b32 v93, 0x7ffffff0
    v_cmp_gt_u32 vcc, 32, v1
    s_mov_b32 s24, 0xffff0000
    s_mov_b32 s25, 0
    v_cndmask_b32 v92, v93, v92, vcc
    v_cmp_eq_u32 vcc, 192, v0
    s_mov_b32 s26, 0
    s_mov_b32 s27, 0xffff
    v_cndmask_b32 v12, v93, v12, vcc
    s_mov_b32 s28, 0
    s_mov_b32 s29, 0xffff0000
    s_sub_u32 s64, s75, 128
    s_lshl_b32 s61, s64, 2
    s_add_u32 s61, s61, s70
    s_lshl_b32 s61, s61, 12
    v_lshlrev_b32 v14, 4, v1
    s_lshl_b32 s62, s70, 12
    s_add_u32 s62, s62, 655360
    v_lshrrev_b32 v15, 3, v1
    v_lshlrev_b32 v15, 7, v15
    v_and_b32 v16, 3, v1
    v_lshlrev_b32 v16, 2, v16
    v_and_b32 v17, 1, v3
    v_lshl_add_u32 v16, v17, 1, v16
    v_lshrrev_b32 v17, 1, v3
    v_add_u32 v16, v16, v17
    s_mul_i32 s63, s70, 1280
    s_lshl_b32 s65, s64, 5
    s_add_u32 s63, s63, s65
    v_lshl_add_u32 v17, v16, 1, s63
    s_lshl_b32 s65, s70, 6
    v_lshl_add_u32 v19, v16, 2, s65
    s_mov_b32 s32, s54
    s_mov_b32 s33, s55
    s_mov_b32 s34, 5120
    s_mov_b32 s35, 0x20000
    s_cmp_ge_u32 s64, 40
    s_cbranch_scc1 L_nopre
    buffer_load_ushort v18, v17, s[20:23], 0 offen
L_gw:
    s_sleep 8
    ds_read_b32 v20, v31 offset:19548
    s_waitcnt lgkmcnt(0)
    v_cmp_ne_u32 vcc, 1, v20
    s_nop 1
    s_cbranch_vccnz L_gw
    ds_read_b32 v19, v19 offset:19552
    s_branch L_ml1
L_ml:
    s_cmp_eq_u32 s94, 0
    s_cbranch_scc1 L_ml_x
    s_sub_u32 s94, s94, 1
    s_sleep 32
L_ml1:
    buffer_load_dwordx4 v[52:55], v15, s[16:19], s62 offen offset:0 sc1
    buffer_load_dwordx4 v[56:59], v15, s[16:19], s62 offen offset:1024 sc1
    buffer_load_dwordx4 v[60:63], v15, s[16:19], s62 offen offset:2048 sc1
    buffer_load_dwordx4 v[64:67], v15, s[16:19], s62 offen offset:3072 sc1
    s_waitcnt vmcnt(0)
    v_max3_u32 v20, v52, v53, v54
    v_max3_u32 v21, v55, v56, v57
    v_max3_u32 v20, v20, v58, v59
    v_max3_u32 v21, v21, v60, v61
    v_max3_u32 v20, v20, v62, v63
    v_max3_u32 v21, v21, v64, v65
    v_max3_u32 v20, v20, v66, v67
    v_max_u32 v20, v20, v21
    v_cmp_eq_u32 vcc, -1, v20
    s_nop 1
    s_cbranch_vccnz L_ml
L_ml_x:
    v_bfe_u32 v20, v1, 2, 1
    v_cmp_eq_u32 vcc, 1, v20
    v_max_f32 v21, v52, v54
    v_sub_f32 v52, v52, v21
    v_sub_f32 v54, v54, v21
    v_mul_f32 v52, s68, v52
    v_mul_f32 v54, s68, v54
    v_exp_f32 v52, v52
    v_exp_f32 v54, v54
    v_max_f32 v21, v56, v58
    v_sub_f32 v56, v56, v21
    v_sub_f32 v58, v58, v21
    v_mul_f32 v56, s68, v56
    v_mul_f32 v58, s68, v58
    v_exp_f32 v56, v56
    v_exp_f32 v58, v58
    v_max_f32 v21, v60, v62
    v_sub_f32 v60, v60, v21
    v_sub_f32 v62, v62, v21
    v_mul_f32 v60, s68, v60
    v_mul_f32 v62, s68, v62
    v_exp_f32 v60, v60
    v_exp_f32 v62, v62
    v_max_f32 v21, v64, v66
    v_sub_f32 v64, v64, v21
    v_sub_f32 v66, v66, v21
    v_mul_f32 v64, s68, v64
    v_mul_f32 v66, s68, v66
    v_exp_f32 v64, v64
    v_exp_f32 v66, v66
    s_nop 0
    v_mul_f32 v53, v53, v52
    v_fmac_f32 v53, v55, v54
    v_rcp_f32 v53, v53
    v_cndmask_b32 v52, v52, v54, vcc
    v_mul_f32 v57, v57, v56
    v_fmac_f32 v57, v59, v58
    v_rcp_f32 v57, v57
    v_cndmask_b32 v56, v56, v58, vcc
    v_mul_f32 v61, v61, v60
    v_fmac_f32 v61, v63, v62
    v_rcp_f32 v61, v61
    v_cndmask_b32 v60, v60, v62, vcc
    v_mul_f32 v65, v65, v64
    v_fmac_f32 v65, v67, v66
    v_rcp_f32 v65, v65
    v_cndmask_b32 v64, v64, v66, vcc
    s_nop 0
    v_mul_f32 v4, v52, v53
    v_mul_f32 v5, v56, v57
    v_mul_f32 v6, v60, v61
    v_mul_f32 v7, v64, v65
    v_lshlrev_b32 v18, 16, v18
    s_waitcnt lgkmcnt(0)
L_nopre:
    s_waitcnt vmcnt(0)
    s_barrier
L_tail:
    ds_read_b128 v[36:39], v30 offset:18432
    ds_read_b128 v[40:43], v30 offset:18496
    ds_read_b128 v[44:47], v30 offset:18560
    ds_read_b128 v[48:51], v30 offset:18624
    ds_read_b128 v[20:23], v31 offset:19456
    s_waitcnt lgkmcnt(4)
    v_mfma_f32_16x16x32_bf16 v[52:55], v[36:39], v[96:99], 0
    s_waitcnt lgkmcnt(3)
    v_mfma_f32_16x16x32_bf16 v[52:55], v[40:43], v[100:103], v[52:55]
    s_waitcnt lgkmcnt(2)
    v_mfma_f32_16x16x32_bf16 v[52:55], v[44:47], v[104:107], v[52:55]
    s_waitcnt lgkmcnt(1)
    v_mfma_f32_16x16x32_bf16 v[52:55], v[48:51], v[108:111], v[52:55]
    s_waitcnt lgkmcnt(0)
    v_max3_f32 v28, v20, v21, v22
    v_max_f32 v28, v28, v23
    v_mfma_f32_16x16x32_bf16 v[56:59], v[36:39], v[112:115], 0
    v_sub_f32 v20, v20, v28
    v_sub_f32 v21, v21, v28
    v_mfma_f32_16x16x32_bf16 v[56:59], v[40:43], v[116:119], v[56:59]
    v_sub_f32 v22, v22, v28
    v_sub_f32 v23, v23, v28
    v_mfma_f32_16x16x32_bf16 v[56:59], v[44:47], v[120:123], v[56:59]
    v_mul_f32 v20, s68, v20
    v_mul_f32 v21, s68, v21
    v_mfma_f32_16x16x32_bf16 v[56:59], v[48:51], v[124:127], v[56:59]
    v_mul_f32 v22, s68, v22
    v_mul_f32 v23, s68, v23
    v_mfma_f32_16x16x32_bf16 v[60:63], v[36:39], v[128:131], 0
    v_exp_f32 v20, v20
    v_mfma_f32_16x16x32_bf16 v[60:63], v[40:43], v[132:135], v[60:63]
    v_exp_f32 v21, v21
    v_mfma_f32_16x16x32_bf16 v[60:63], v[44:47], v[136:139], v[60:63]
    v_exp_f32 v22, v22
    v_mfma_f32_16x16x32_bf16 v[60:63], v[48:51], v[140:143], v[60:63]
    v_exp_f32 v23, v23
    v_mfma_f32_16x16x32_bf16 v[64:67], v[36:39], v[144:147], 0
    v_mul_f32 v33, v52, v20
    v_fmac_f32 v33, v53, v21
    v_mfma_f32_16x16x32_bf16 v[64:67], v[40:43], v[148:151], v[64:67]
    v_fmac_f32 v33, v54, v22
    v_fmac_f32 v33, v55, v23
    v_mfma_f32_16x16x32_bf16 v[64:67], v[44:47], v[152:155], v[64:67]
    v_mul_f32 v56, v56, v20
    v_fmac_f32 v56, v57, v21
    v_mfma_f32_16x16x32_bf16 v[64:67], v[48:51], v[156:159], v[64:67]
    v_fmac_f32 v56, v58, v22
    v_fmac_f32 v56, v59, v23
    v_mfma_f32_16x16x32_bf16 v[68:71], v[36:39], v[160:163], 0
    v_cndmask_b32 v33, v33, v56, s[24:25]
    v_mul_f32 v60, v60, v20
    v_mfma_f32_16x16x32_bf16 v[68:71], v[40:43], v[164:167], v[68:71]
    v_fmac_f32 v60, v61, v21
    v_fmac_f32 v60, v62, v22
    v_mfma_f32_16x16x32_bf16 v[68:71], v[44:47], v[168:171], v[68:71]
    v_fmac_f32 v60, v63, v23
    v_cndmask_b32 v33, v33, v60, s[26:27]
    v_mfma_f32_16x16x32_bf16 v[68:71], v[48:51], v[172:175], v[68:71]
    v_mul_f32 v64, v64, v20
    v_fmac_f32 v64, v65, v21
    v_mfma_f32_16x16x32_bf16 v[72:75], v[36:39], v[176:179], 0
    v_fmac_f32 v64, v66, v22
    v_fmac_f32 v64, v67, v23
    v_mfma_f32_16x16x32_bf16 v[72:75], v[40:43], v[180:183], v[72:75]
    v_cndmask_b32 v33, v33, v64, s[28:29]
    v_min_u32 v33, -2, v33
    v_mfma_f32_16x16x32_bf16 v[72:75], v[44:47], v[184:187], v[72:75]
    buffer_store_dword v33, v32, s[16:19], 0 offen sc1
    v_mul_f32 v34, v68, v20
    v_mfma_f32_16x16x32_bf16 v[72:75], v[48:51], v[188:191], v[72:75]
    v_fmac_f32 v34, v69, v21
    v_fmac_f32 v34, v70, v22
    v_mfma_f32_16x16x32_bf16 v[76:79], v[36:39], v[192:195], 0
    v_fmac_f32 v34, v71, v23
    v_mfma_f32_16x16x32_bf16 v[76:79], v[40:43], v[196:199], v[76:79]
    v_mfma_f32_16x16x32_bf16 v[76:79], v[44:47], v[200:203], v[76:79]
    v_mfma_f32_16x16x32_bf16 v[76:79], v[48:51], v[204:207], v[76:79]
    v_mfma_f32_16x16x32_bf16 v[80:83], v[36:39], v[208:211], 0
    v_mul_f32 v72, v72, v20
    v_fmac_f32 v72, v73, v21
    v_mfma_f32_16x16x32_bf16 v[80:83], v[40:43], v[212:215], v[80:83]
    v_fmac_f32 v72, v74, v22
    v_fmac_f32 v72, v75, v23
    v_mfma_f32_16x16x32_bf16 v[80:83], v[44:47], v[216:219], v[80:83]
    v_cndmask_b32 v34, v34, v72, s[24:25]
    v_mul_f32 v76, v76, v20
    v_mfma_f32_16x16x32_bf16 v[80:83], v[48:51], v[220:223], v[80:83]
    v_fmac_f32 v76, v77, v21
    v_fmac_f32 v76, v78, v22
    v_mfma_f32_16x16x32_bf16 v[84:87], v[36:39], v[224:227], 0
    v_fmac_f32 v76, v79, v23
    v_cndmask_b32 v34, v34, v76, s[26:27]
    v_mfma_f32_16x16x32_bf16 v[84:87], v[40:43], v[228:231], v[84:87]
    v_mfma_f32_16x16x32_bf16 v[84:87], v[44:47], v[232:235], v[84:87]
    v_mfma_f32_16x16x32_bf16 v[84:87], v[48:51], v[236:239], v[84:87]
    v_mul_f32 v80, v80, v20
    v_fmac_f32 v80, v81, v21
    v_mfma_f32_16x16x32_bf16 v[88:91], v[36:39], v[240:243], 0
    v_fmac_f32 v80, v82, v22
    v_fmac_f32 v80, v83, v23
    v_mfma_f32_16x16x32_bf16 v[88:91], v[40:43], v[244:247], v[88:91]
    v_cndmask_b32 v34, v34, v80, s[28:29]
    v_min_u32 v34, -2, v34
    v_mfma_f32_16x16x32_bf16 v[88:91], v[44:47], v[248:251], v[88:91]
    buffer_store_dword v34, v32, s[16:19], s66 offen sc1
    v_mul_f32 v35, v84, v20
    v_mfma_f32_16x16x32_bf16 v[88:91], v[48:51], v[252:255], v[88:91]
    v_fmac_f32 v35, v85, v21
    v_fmac_f32 v35, v86, v22
    v_fmac_f32 v35, v87, v23
    s_nop 4
    v_mul_f32 v88, v88, v20
    v_fmac_f32 v88, v89, v21
    v_fmac_f32 v88, v90, v22
    v_fmac_f32 v88, v91, v23
    v_cndmask_b32 v35, v35, v88, s[24:25]
    v_min_u32 v35, -2, v35
    buffer_store_dword v35, v92, s[16:19], 0 offen sc1
    s_cmp_ge_u32 s64, 40
    s_cbranch_scc1 L_fin
    s_branch L_pt1
L_pt:
    s_cmp_eq_u32 s94, 0
    s_cbranch_scc1 L_pt_x
    s_sub_u32 s94, s94, 1
    s_sleep 2
L_pt1:
    buffer_load_dwordx4 v[96:99], v14, s[16:19], s61 offen offset:0 sc1
    buffer_load_dwordx4 v[100:103], v14, s[16:19], s61 offen offset:1024 sc1
    buffer_load_dwordx4 v[104:107], v14, s[16:19], s61 offen offset:2048 sc1
    buffer_load_dwordx4 v[108:111], v14, s[16:19], s61 offen offset:3072 sc1
    s_waitcnt vmcnt(0)
    v_max3_u32 v20, v96, v97, v98
    v_max3_u32 v21, v99, v100, v101
    v_max3_u32 v20, v20, v102, v103
    v_max3_u32 v21, v21, v104, v105
    v_max3_u32 v20, v20, v106, v107
    v_max3_u32 v21, v21, v108, v109
    v_max3_u32 v20, v20, v110, v111
    v_max_u32 v20, v20, v21
    v_cmp_eq_u32 vcc, -1, v20
    v_mul_f32 v24, v96, v4
    v_mul_f32 v25, v97, v4
    v_mul_f32 v26, v98, v4
    v_mul_f32 v27, v99, v4
    v_fmac_f32 v24, v100, v5
    v_fmac_f32 v25, v101, v5
    v_fmac_f32 v26, v102, v5
    v_fmac_f32 v27, v103, v5
    v_fmac_f32 v24, v104, v6
    v_fmac_f32 v25, v105, v6
    v_fmac_f32 v26, v106, v6
    v_fmac_f32 v27, v107, v6
    v_fmac_f32 v24, v108, v7
    v_fmac_f32 v25, v109, v7
    v_fmac_f32 v26, v110, v7
    v_fmac_f32 v27, v111, v7
    s_cbranch_vccnz L_pt
L_pt_x:
    s_nop 0
    v_permlane32_swap_b32 v24, v25
    v_permlane32_swap_b32 v26, v27
    v_add_f32 v24, v24, v25
    v_add_f32 v26, v26, v27
    s_nop 1
    v_permlane16_swap_b32 v24, v26
    v_add_f32 v24, v24, v26
    s_nop 1
    v_add_f32_dpp v24, v24, v24 row_ror:4 row_mask:0xf bank_mask:0xf
    s_nop 1
    v_add_f32_dpp v24, v24, v24 row_ror:8 row_mask:0xf bank_mask:0xf
    v_cvt_pk_bf16_f32 v24, v24, v24
    v_and_b32 v24, 0xffff0000, v24
    v_mul_f32 v24, v24, v19
    v_cvt_pk_bf16_f32 v24, v24, v24
    v_and_b32 v24, 0xffff0000, v24
    v_add_f32 v24, v24, v18
    v_cvt_pk_bf16_f32 v24, v24, v24
    s_mov_b32 exec_lo, 0x000f000f
    s_mov_b32 exec_hi, 0x000f000f
    buffer_store_short v24, v17, s[32:35], 0 offen
    s_mov_b64 exec, -1
L_fin:
L_end:
    s_endpgm

.section .rodata,"a"
.p2align 6
.amdhsa_kernel recurrent_scan__mha_block_cached__geglu_ffn__decode_kernel
  .amdhsa_next_free_vgpr 256
  .amdhsa_next_free_sgpr 96
  .amdhsa_accum_offset 256
  .amdhsa_group_segment_fixed_size 0
  .amdhsa_kernarg_size 96
  .amdhsa_user_sgpr_count 2
  .amdhsa_user_sgpr_kernarg_segment_ptr 1
  .amdhsa_system_sgpr_workgroup_id_x 1
  .amdhsa_float_denorm_mode_32 3
.end_amdhsa_kernel
```
